```python
import torch

def _softmax(x, axis=-1):
    return torch.softmax(x, dim=axis)
def _gelu(x):
    return torch.nn.functional.gelu(x, approximate="tanh")
def _silu(x):
    return torch.nn.functional.silu(x)
def _sigmoid(x):
    return torch.sigmoid(x)
def _layernorm(x, axis=-1, eps=1e-5):
    m = x.mean(dim=axis, keepdim=True)
    v = x.var(dim=axis, keepdim=True, unbiased=False)
    return (x - m) / torch.sqrt(v + eps)
def _scatter_add(tgt, idx, src, axis=0):
    return tgt.clone().index_add_(axis, idx, src)
def _segment_sum(src, seg, n):
    out = torch.zeros((n,) + src.shape[1:], dtype=src.dtype)
    return out.index_add_(0, seg, src)
def _pad(x, pw):
    flat = tuple(v for pair in reversed(pw) for v in pair)
    return torch.nn.functional.pad(x, flat)

kernel_name = 'parallel_sum__compressed_kv_cla__geglu_ffn__decode'

def setup_inputs():

    _w = (lambda a: (lambda t: t.to(torch.bfloat16) if t.is_floating_point() else t)(torch.as_tensor(a)))
    def _A_setup():
        B, H, Sq, Sk, D, M = 8, 32, 1, 4096, 128, 512
        Dc = 4 * D
        return {
            "x": _w((lambda *s: torch.randn(*s, dtype=torch.bfloat16) * 0.05)(B, Sq, M)),
            "c_kv": _w((lambda *s: torch.randn(*s, dtype=torch.bfloat16) * 1.6)(B, Sk, Dc)),
            "w_q": _w((lambda *s: torch.randn(*s, dtype=torch.bfloat16) * 3.2)(M, H, D) * (M ** -0.5)),
            "w_uk": _w((lambda *s: torch.randn(*s, dtype=torch.bfloat16) * 3.2)(Dc, H, D) * (Dc ** -0.5)),
            "w_uv": _w((lambda *s: torch.randn(*s, dtype=torch.bfloat16) * 1.6)(Dc, H, D) * (Dc ** -0.5)),
            "w_o": _w((lambda *s: torch.randn(*s, dtype=torch.bfloat16) * 1.6)(H, D, M) * ((H * D) ** -0.5)),
        }
    _A_in = _A_setup()

    def _B_setup():
        B, S, D, F = 8, 1, 512, 1376
        return {
            "x": _w((lambda *s: torch.randn(*s, dtype=torch.bfloat16) * 0.05)(B, S, D)),
            "w_gate": _w((lambda *s: torch.randn(*s, dtype=torch.bfloat16) * 0.1)(D, F)),
            "w_up": _w((lambda *s: torch.randn(*s, dtype=torch.bfloat16) * 0.1)(D, F)),
            "w_down": _w((lambda *s: torch.randn(*s, dtype=torch.bfloat16) * 0.1)(F, D)),
        }
    _B_in = _B_setup()

    return {
        "A_x": _A_in["x"],
        "A_c_kv": _A_in["c_kv"],
        "A_w_q": _A_in["w_q"],
        "A_w_uk": _A_in["w_uk"],
        "A_w_uv": _A_in["w_uv"],
        "A_w_o": _A_in["w_o"],
        "B_x": _B_in["x"],
        "B_w_gate": _B_in["w_gate"],
        "B_w_up": _B_in["w_up"],
        "B_w_down": _B_in["w_down"],
    }

def reference(A_x, A_c_kv, A_w_q, A_w_uk, A_w_uv, A_w_o, B_x, B_w_gate, B_w_up, B_w_down):
    def _A_ref(x, c_kv, w_q, w_uk, w_uv, w_o):
        B, Sq, M = x.shape[0], x.shape[1], x.shape[2]
        Sk = c_kv.shape[1]
        H, D = w_q.shape[1], w_q.shape[2]
        q = torch.einsum("bqm,mhd->bhqd", x, w_q)
        k = torch.einsum("bkc,chd->bhkd", c_kv, w_uk)
        v = torch.einsum("bkc,chd->bhkd", c_kv, w_uv)
        scores = torch.einsum("bhqd,bhkd->bhqk", q, k) * (D ** -0.5)
        off = Sk - Sq
        qi = torch.arange(Sq)[:, None]
        kj = torch.arange(Sk)[None, :]
        cmask = kj <= (qi + off)
        scores = torch.where(cmask[None, None], scores, -1e9)
        p = _softmax(scores, axis=-1)
        ctx = torch.einsum("bhqk,bhkd->bhqd", p, v)
        return torch.einsum("bhqd,hdm->bqm", ctx, w_o)

    def _B_ref(x, w_gate, w_up, w_down):
        return (_gelu(x @ w_gate) * (x @ w_up)) @ w_down

    x = A_x
    xn = _layernorm(x, axis=-1)
    return x + _A_ref(xn, A_c_kv, A_w_q, A_w_uk, A_w_uv, A_w_o) + _B_ref(xn, B_w_gate, B_w_up, B_w_down)
```

```asm
; @launch grid=(256,1,1) block=(512,1,1) lds=163840
.amdgcn_target "amdgcn-amd-amdhsa--gfx950"
.text
.globl parallel_sum__compressed_kv_cla__geglu_ffn__decode_kernel
.p2align 8
.type parallel_sum__compressed_kv_cla__geglu_ffn__decode_kernel,@function
parallel_sum__compressed_kv_cla__geglu_ffn__decode_kernel:
    s_cmp_ge_u32 s2, 256
    s_cbranch_scc1 KP_EXIT
    s_load_dwordx4 s[4:7], s[0:1], 0
    s_load_dwordx2 s[28:29], s[0:1], 16
    s_load_dwordx4 s[8:11], s[0:1], 24
    s_load_dwordx2 s[12:13], s[0:1], 40
    s_load_dwordx2 s[36:37], s[0:1], 56
    s_load_dwordx2 s[40:41], s[0:1], 64
    s_load_dwordx2 s[14:15], s[0:1], 72
    s_load_dwordx2 s[16:17], s[0:1], 80
    s_load_dwordx2 s[44:45], s[0:1], 88
    s_load_dwordx2 s[18:19], s[0:1], 96
    v_lshrrev_b32 v1, 6, v0
    v_and_b32 v2, 63, v0
    v_readfirstlane_b32 s3, v1
    s_nop 3
    s_waitcnt lgkmcnt(0)
    s_mov_b32 s24, s6
    s_and_b32 s25, s7, 0xffff
    s_mov_b32 s26, 33554432
    s_mov_b32 s27, 0x00020000
    s_cmp_ge_u32 s3, 4
    s_cbranch_scc1 KP_LOADER
    v_lshlrev_b32 v30, 4, v2
    v_mov_b32 v248, 0xff
    s_and_b32 s45, s45, 0xffff
    s_mov_b32 s46, 256
    s_mov_b32 s47, 0x00020000
    s_or_b32 s70, s2, s3
    s_cmp_lg_u32 s70, 0
    s_cbranch_scc1 KP_NONON
    s_memrealtime s[70:71]
    s_waitcnt lgkmcnt(0)
    s_or_b32 s70, s70, 1
    v_mov_b32 v22, s70
    v_mov_b32 v23, 0
    s_mov_b64 exec, 1
    buffer_store_dword v22, v23, s[44:47], 0 offen sc1
    s_mov_b64 exec, -1
KP_NONON:
    s_mov_b32 s20, s4
    s_and_b32 s21, s5, 0xffff
    s_mov_b32 s22, 8192
    s_mov_b32 s23, 0x00020000
    v_lshrrev_b32 v60, 5, v2
    s_lshl_b32 s70, s3, 1
    v_add_u32 v60, s70, v60
    v_and_b32 v61, 31, v2
    v_lshlrev_b32 v62, 5, v61
    v_lshl_add_u32 v62, v60, 10, v62
    buffer_load_dwordx4 v[64:67], v62, s[20:23], 0 offen
    buffer_load_dwordx4 v[68:71], v62, s[20:23], 0 offen offset:16
    v_and_b32 v3, 15, v2
    v_lshrrev_b32 v4, 4, v2
    v_and_b32 v5, 7, v2
    v_lshrrev_b32 v6, 2, v2
    v_and_b32 v6, 3, v6
    v_and_b32 v7, 3, v2
    s_lshr_b32 s73, s2, 3
    s_and_b32 s68, s2, 7
    s_lshr_b32 s74, s2, 1
    s_and_b32 s74, s74, 3
    s_and_b32 s75, s2, 1
    v_lshrrev_b32 v8, 3, v2
    s_and_b32 s29, s29, 0xffff
    s_mov_b32 s30, 4194304
    s_mov_b32 s31, 0x00020000
    v_lshrrev_b32 v9, 1, v8
    v_and_b32 v9, 1, v9
    v_lshlrev_b32 v9, 1, v9
    v_xor_b32 v9, v9, v5
    v_lshlrev_b32 v9, 4, v9
    v_lshl_add_u32 v10, v8, 13, v9
    v_xor_b32 v11, 64, v10
    s_lshl_b32 s70, s74, 20
    s_lshl_b32 s71, s3, 18
    s_add_u32 s70, s70, s71
    s_lshl_b32 s71, s73, 8
    s_add_u32 s70, s70, s71
    s_lshl_b32 s71, s75, 7
    s_add_u32 s70, s70, s71
    s_lshl_b32 s71, s3, 12
    s_add_u32 s71, s71, 131072
    s_mov_b32 m0, s71
    s_add_u32 s71, s71, 1024
    buffer_load_dwordx4 v10, s[28:31], s70 offen nt lds
    s_add_u32 s70, s70, 65536
    s_mov_b32 m0, s71
    s_add_u32 s71, s71, 1024
    buffer_load_dwordx4 v11, s[28:31], s70 offen nt lds
    s_add_u32 s70, s70, 65536
    s_mov_b32 m0, s71
    s_add_u32 s71, s71, 1024
    buffer_load_dwordx4 v10, s[28:31], s70 offen nt lds
    s_add_u32 s70, s70, 65536
    s_mov_b32 m0, s71
    s_add_u32 s71, s71, 1024
    buffer_load_dwordx4 v11, s[28:31], s70 offen nt lds
    s_add_u32 s70, s70, 65536
    s_mov_b32 s32, s8
    s_and_b32 s33, s9, 0xffff
    s_mov_b32 s34, 4194304
    s_mov_b32 s35, 0x00020000
    v_lshlrev_b32 v12, 13, v3
    v_lshl_add_u32 v12, v4, 4, v12
    s_lshl_b32 s70, s68, 19
    s_lshl_b32 s71, s3, 17
    s_add_u32 s70, s70, s71
    s_lshl_b32 s71, s73, 8
    s_add_u32 s70, s70, s71
    buffer_load_dwordx4 v[104:107], v12, s[32:35], s70 offen offset:0 nt
    buffer_load_dwordx4 v[108:111], v12, s[32:35], s70 offen offset:64 nt
    buffer_load_dwordx4 v[112:115], v12, s[32:35], s70 offen offset:128 nt
    buffer_load_dwordx4 v[116:119], v12, s[32:35], s70 offen offset:192 nt
    s_cmp_ge_u32 s3, 2
    s_cselect_b32 s76, s40, s36
    s_cselect_b32 s77, s41, s37
    s_and_b32 s77, s77, 0xffff
    s_mov_b32 s78, 1409024
    s_mov_b32 s79, 0x00020000
    s_mov_b32 s70, 2752
    v_mul_lo_u32 v14, v8, s70
    v_lshl_add_u32 v14, v5, 4, v14
    s_and_b32 s70, s3, 1
    s_lshl_b32 s70, s70, 5
    s_lshl_b32 s71, s68, 6
    s_add_u32 s70, s70, s71
    s_mul_i32 s70, s70, 2752
    s_lshl_b32 s71, s73, 7
    s_add_u32 s70, s70, s71
    s_cmp_ge_u32 s2, 176
    s_cselect_b32 s70, 0x40000000, s70
    buffer_load_dwordx4 v[120:123], v14, s[76:79], s70 offen nt
    s_add_u32 s70, s70, 22016
    buffer_load_dwordx4 v[124:127], v14, s[76:79], s70 offen nt
    s_add_u32 s70, s70, 22016
    buffer_load_dwordx4 v[128:131], v14, s[76:79], s70 offen nt
    s_add_u32 s70, s70, 22016
    buffer_load_dwordx4 v[132:135], v14, s[76:79], s70 offen nt
    s_add_u32 s70, s70, 22016
    v_mov_b32 v226, 154624
    v_mov_b32 v227, 1
    v_mov_b32 v228, 0
    ds_write_b32 v226, v228
    ds_write_b32 v226, v228 offset:4
    ds_write_b32 v226, v228 offset:8
    ds_write_b32 v226, v228 offset:12
    s_waitcnt lgkmcnt(0)
    s_barrier
    v_lshlrev_b32 v13, 1, v4
    v_xor_b32 v13, v13, v3
    v_lshlrev_b32 v13, 4, v13
    v_lshrrev_b32 v22, 5, v0
    v_and_b32 v23, 31, v0
    v_lshrrev_b32 v19, 2, v23
    v_lshlrev_b32 v19, 9, v19
    v_lshl_add_u32 v19, v22, 6, v19
    v_and_b32 v14, 3, v23
    v_lshl_add_u32 v19, v14, 4, v19
    s_mov_b32 s70, 288
    v_mul_lo_u32 v20, v22, s70
    v_lshl_add_u32 v20, v23, 3, v20
    v_mul_lo_u32 v16, v5, s70
    v_lshl_add_u32 v16, v4, 4, v16
    v_lshlrev_b32 v29, 6, v5
    v_lshl_add_u32 v29, v4, 4, v29
    s_waitcnt vmcnt(12)
    v_lshlrev_b32 v72, 16, v64
    v_and_b32 v73, 0xffff0000, v64
    v_lshlrev_b32 v74, 16, v65
    v_and_b32 v75, 0xffff0000, v65
    v_lshlrev_b32 v76, 16, v66
    v_and_b32 v77, 0xffff0000, v66
    v_lshlrev_b32 v78, 16, v67
    v_and_b32 v79, 0xffff0000, v67
    v_lshlrev_b32 v80, 16, v68
    v_and_b32 v81, 0xffff0000, v68
    v_lshlrev_b32 v82, 16, v69
    v_and_b32 v83, 0xffff0000, v69
    v_lshlrev_b32 v84, 16, v70
    v_and_b32 v85, 0xffff0000, v70
    v_lshlrev_b32 v86, 16, v71
    v_and_b32 v87, 0xffff0000, v71
    v_add_f32 v88, v72, v73
    v_add_f32 v88, v88, v74
    v_add_f32 v88, v88, v75
    v_add_f32 v88, v88, v76
    v_add_f32 v88, v88, v77
    v_add_f32 v88, v88, v78
    v_add_f32 v88, v88, v79
    v_add_f32 v88, v88, v80
    v_add_f32 v88, v88, v81
    v_add_f32 v88, v88, v82
    v_add_f32 v88, v88, v83
    v_add_f32 v88, v88, v84
    v_add_f32 v88, v88, v85
    v_add_f32 v88, v88, v86
    v_add_f32 v88, v88, v87
    ds_swizzle_b32 v89, v88 offset:1055
    s_waitcnt lgkmcnt(0)
    v_add_f32 v88, v88, v89
    ds_swizzle_b32 v89, v88 offset:2079
    s_waitcnt lgkmcnt(0)
    v_add_f32 v88, v88, v89
    ds_swizzle_b32 v89, v88 offset:4127
    s_waitcnt lgkmcnt(0)
    v_add_f32 v88, v88, v89
    ds_swizzle_b32 v89, v88 offset:8223
    s_waitcnt lgkmcnt(0)
    v_add_f32 v88, v88, v89
    ds_swizzle_b32 v89, v88 offset:16415
    s_waitcnt lgkmcnt(0)
    v_add_f32 v88, v88, v89
    v_mul_f32 v90, 0x3b000000, v88
    v_sub_f32 v89, v72, v90
    v_mul_f32 v91, v89, v89
    v_sub_f32 v89, v73, v90
    v_fmac_f32 v91, v89, v89
    v_sub_f32 v89, v74, v90
    v_fmac_f32 v91, v89, v89
    v_sub_f32 v89, v75, v90
    v_fmac_f32 v91, v89, v89
    v_sub_f32 v89, v76, v90
    v_fmac_f32 v91, v89, v89
    v_sub_f32 v89, v77, v90
    v_fmac_f32 v91, v89, v89
    v_sub_f32 v89, v78, v90
    v_fmac_f32 v91, v89, v89
    v_sub_f32 v89, v79, v90
    v_fmac_f32 v91, v89, v89
    v_sub_f32 v89, v80, v90
    v_fmac_f32 v91, v89, v89
    v_sub_f32 v89, v81, v90
    v_fmac_f32 v91, v89, v89
    v_sub_f32 v89, v82, v90
    v_fmac_f32 v91, v89, v89
    v_sub_f32 v89, v83, v90
    v_fmac_f32 v91, v89, v89
    v_sub_f32 v89, v84, v90
    v_fmac_f32 v91, v89, v89
    v_sub_f32 v89, v85, v90
    v_fmac_f32 v91, v89, v89
    v_sub_f32 v89, v86, v90
    v_fmac_f32 v91, v89, v89
    v_sub_f32 v89, v87, v90
    v_fmac_f32 v91, v89, v89
    ds_swizzle_b32 v89, v91 offset:1055
    s_waitcnt lgkmcnt(0)
    v_add_f32 v91, v91, v89
    ds_swizzle_b32 v89, v91 offset:2079
    s_waitcnt lgkmcnt(0)
    v_add_f32 v91, v91, v89
    ds_swizzle_b32 v89, v91 offset:4127
    s_waitcnt lgkmcnt(0)
    v_add_f32 v91, v91, v89
    ds_swizzle_b32 v89, v91 offset:8223
    s_waitcnt lgkmcnt(0)
    v_add_f32 v91, v91, v89
    ds_swizzle_b32 v89, v91 offset:16415
    s_waitcnt lgkmcnt(0)
    v_add_f32 v91, v91, v89
    v_mul_f32 v91, 0x3b000000, v91
    v_cvt_pk_bf16_f32 v89, v90, v91
    v_lshlrev_b32 v90, 16, v89
    v_and_b32 v91, 0xffff0000, v89
    v_add_f32 v91, 0x3727c5ac, v91
    v_cvt_pk_bf16_f32 v88, v91, v91
    v_lshlrev_b32 v91, 16, v88
    v_and_b32 v89, 0xffff0000, v88
    v_sqrt_f32 v91, v91
    s_nop 0
    v_cvt_pk_bf16_f32 v88, v91, v91
    v_lshlrev_b32 v91, 16, v88
    v_and_b32 v89, 0xffff0000, v88
    v_rcp_f32 v92, v91
    s_nop 0
    v_sub_f32 v72, v72, v90
    v_sub_f32 v73, v73, v90
    v_cvt_pk_bf16_f32 v89, v72, v73
    v_lshlrev_b32 v72, 16, v89
    v_and_b32 v73, 0xffff0000, v89
    v_sub_f32 v74, v74, v90
    v_sub_f32 v75, v75, v90
    v_cvt_pk_bf16_f32 v89, v74, v75
    v_lshlrev_b32 v74, 16, v89
    v_and_b32 v75, 0xffff0000, v89
    v_sub_f32 v76, v76, v90
    v_sub_f32 v77, v77, v90
    v_cvt_pk_bf16_f32 v89, v76, v77
    v_lshlrev_b32 v76, 16, v89
    v_and_b32 v77, 0xffff0000, v89
    v_sub_f32 v78, v78, v90
    v_sub_f32 v79, v79, v90
    v_cvt_pk_bf16_f32 v89, v78, v79
    v_lshlrev_b32 v78, 16, v89
    v_and_b32 v79, 0xffff0000, v89
    v_sub_f32 v80, v80, v90
    v_sub_f32 v81, v81, v90
    v_cvt_pk_bf16_f32 v89, v80, v81
    v_lshlrev_b32 v80, 16, v89
    v_and_b32 v81, 0xffff0000, v89
    v_sub_f32 v82, v82, v90
    v_sub_f32 v83, v83, v90
    v_cvt_pk_bf16_f32 v89, v82, v83
    v_lshlrev_b32 v82, 16, v89
    v_and_b32 v83, 0xffff0000, v89
    v_sub_f32 v84, v84, v90
    v_sub_f32 v85, v85, v90
    v_cvt_pk_bf16_f32 v89, v84, v85
    v_lshlrev_b32 v84, 16, v89
    v_and_b32 v85, 0xffff0000, v89
    v_sub_f32 v86, v86, v90
    v_sub_f32 v87, v87, v90
    v_cvt_pk_bf16_f32 v89, v86, v87
    v_lshlrev_b32 v86, 16, v89
    v_and_b32 v87, 0xffff0000, v89
    v_mul_f32 v89, v72, v92
    v_fma_f32 v88, -v89, v91, v72
    v_fma_f32 v72, v88, v92, v89
    v_mul_f32 v89, v73, v92
    v_fma_f32 v88, -v89, v91, v73
    v_fma_f32 v73, v88, v92, v89
    v_mul_f32 v89, v74, v92
    v_fma_f32 v88, -v89, v91, v74
    v_fma_f32 v74, v88, v92, v89
    v_mul_f32 v89, v75, v92
    v_fma_f32 v88, -v89, v91, v75
    v_fma_f32 v75, v88, v92, v89
    v_mul_f32 v89, v76, v92
    v_fma_f32 v88, -v89, v91, v76
    v_fma_f32 v76, v88, v92, v89
    v_mul_f32 v89, v77, v92
    v_fma_f32 v88, -v89, v91, v77
    v_fma_f32 v77, v88, v92, v89
    v_mul_f32 v89, v78, v92
    v_fma_f32 v88, -v89, v91, v78
    v_fma_f32 v78, v88, v92, v89
    v_mul_f32 v89, v79, v92
    v_fma_f32 v88, -v89, v91, v79
    v_fma_f32 v79, v88, v92, v89
    v_mul_f32 v89, v80, v92
    v_fma_f32 v88, -v89, v91, v80
    v_fma_f32 v80, v88, v92, v89
    v_mul_f32 v89, v81, v92
    v_fma_f32 v88, -v89, v91, v81
    v_fma_f32 v81, v88, v92, v89
    v_mul_f32 v89, v82, v92
    v_fma_f32 v88, -v89, v91, v82
    v_fma_f32 v82, v88, v92, v89
    v_mul_f32 v89, v83, v92
    v_fma_f32 v88, -v89, v91, v83
    v_fma_f32 v83, v88, v92, v89
    v_mul_f32 v89, v84, v92
    v_fma_f32 v88, -v89, v91, v84
    v_fma_f32 v84, v88, v92, v89
    v_mul_f32 v89, v85, v92
    v_fma_f32 v88, -v89, v91, v85
    v_fma_f32 v85, v88, v92, v89
    v_mul_f32 v89, v86, v92
    v_fma_f32 v88, -v89, v91, v86
    v_fma_f32 v86, v88, v92, v89
    v_mul_f32 v89, v87, v92
    v_fma_f32 v88, -v89, v91, v87
    v_fma_f32 v87, v88, v92, v89
    v_cvt_pk_bf16_f32 v64, v72, v73
    v_cvt_pk_bf16_f32 v65, v74, v75
    v_cvt_pk_bf16_f32 v66, v76, v77
    v_cvt_pk_bf16_f32 v67, v78, v79
    v_cvt_pk_bf16_f32 v68, v80, v81
    v_cvt_pk_bf16_f32 v69, v82, v83
    v_cvt_pk_bf16_f32 v70, v84, v85
    v_cvt_pk_bf16_f32 v71, v86, v87
    s_mov_b32 s70, 288
    v_mul_lo_u32 v14, v60, s70
    v_and_b32 v15, 7, v61
    v_lshl_add_u32 v14, v15, 5, v14
    v_add_u32 v14, 147456, v14
    v_lshrrev_b32 v15, 3, v61
    v_cmp_eq_u32 vcc, s74, v15
    s_and_saveexec_b64 s[80:81], vcc
    ds_write_b128 v14, v[64:67]
    ds_write_b128 v14, v[68:71] offset:16
    s_mov_b64 exec, s[80:81]
    s_mov_b32 s70, 160
    v_mul_lo_u32 v14, v60, s70
    v_and_b32 v15, 3, v61
    v_lshl_add_u32 v14, v15, 5, v14
    v_add_u32 v14, 149760, v14
    v_lshrrev_b32 v15, 2, v61
    v_cmp_eq_u32 vcc, s68, v15
    s_and_saveexec_b64 s[80:81], vcc
    ds_write_b128 v14, v[64:67]
    ds_write_b128 v14, v[68:71] offset:16
    s_mov_b64 exec, s[80:81]
    v_add_u32 v15, 147456, v16
    s_mov_b32 s70, 160
    v_mul_lo_u32 v17, v5, s70
    v_lshl_add_u32 v17, v4, 4, v17
    v_add_u32 v17, 149760, v17
    s_lshl_b32 s69, s3, 1
    v_lshrrev_b32 v14, 1, v6
    v_and_b32 v18, 1, v4
    v_lshl_add_u32 v14, v18, 1, v14
    v_lshlrev_b32 v14, 1, v14
    v_lshrrev_b32 v18, 1, v7
    v_add_u32 v18, s69, v18
    v_xor_b32 v14, v14, v18
    v_lshl_add_u32 v18, v4, 3, v6
    v_lshlrev_b32 v18, 7, v18
    v_lshl_add_u32 v18, v14, 4, v18
    v_and_b32 v14, 1, v7
    v_lshl_add_u32 v18, v14, 3, v18
    v_add_u32 v18, 131072, v18
    v_mov_b32 v136, 0
    v_mov_b32 v137, 0
    v_mov_b32 v138, 0
    v_mov_b32 v139, 0
    v_mov_b32 v140, 0
    v_mov_b32 v141, 0
    v_mov_b32 v142, 0
    v_mov_b32 v143, 0
    v_mov_b32 v144, 0
    v_mov_b32 v145, 0
    v_mov_b32 v146, 0
    v_mov_b32 v147, 0
    s_waitcnt vmcnt(8)
    s_waitcnt lgkmcnt(0)
    s_mov_b64 exec, 1
    ds_add_u32 v226, v227
    s_mov_b64 exec, -1
WS1:
    ds_read_b32 v228, v226
    s_waitcnt lgkmcnt(0)
    v_readfirstlane_b32 s71, v228
    s_nop 3
    s_cmp_ge_u32 s71, 4
    s_cbranch_scc0 WS1
    ds_read_b128 v[36:39], v15 offset:0
    ds_read_b64_tr_b16 v[40:41], v18 offset:0
    ds_read_b64_tr_b16 v[42:43], v18 offset:512
    ds_read_b128 v[44:47], v15 offset:64
    ds_read_b64_tr_b16 v[48:49], v18 offset:4096
    ds_read_b64_tr_b16 v[50:51], v18 offset:4608
    ds_read_b128 v[52:55], v15 offset:128
    ds_read_b64_tr_b16 v[56:57], v18 offset:8192
    ds_read_b64_tr_b16 v[58:59], v18 offset:8704
    ds_read_b128 v[60:63], v15 offset:192
    ds_read_b64_tr_b16 v[64:65], v18 offset:12288
    ds_read_b64_tr_b16 v[66:67], v18 offset:12800
    s_waitcnt lgkmcnt(9)
    v_mfma_f32_16x16x32_bf16 v[136:139], v[40:43], v[36:39], v[136:139]
    s_waitcnt lgkmcnt(6)
    v_mfma_f32_16x16x32_bf16 v[136:139], v[48:51], v[44:47], v[136:139]
    s_waitcnt lgkmcnt(3)
    v_mfma_f32_16x16x32_bf16 v[136:139], v[56:59], v[52:55], v[136:139]
    s_waitcnt lgkmcnt(0)
    v_mfma_f32_16x16x32_bf16 v[136:139], v[64:67], v[60:63], v[136:139]
KP_NL:
    ds_read_b32 v23, v226 offset:12
    s_waitcnt lgkmcnt(0)
    v_readfirstlane_b32 s100, v23
    s_nop 3
    s_cmp_eq_u32 s100, 0
    s_cbranch_scc1 KP_NL
    s_and_b32 s96, s100, 0xff
    s_lshr_b32 s97, s100, 8
    s_and_b32 s97, s97, 0xff
    s_lshr_b32 s98, s100, 16
    s_and_b32 s98, s98, 0xff
    s_lshr_b32 s99, s100, 24
    v_bfi_b32 v136, v248, s96, v136
    v_bfi_b32 v137, v248, s97, v137
    v_bfi_b32 v138, v248, s98, v138
    v_bfi_b32 v139, v248, s99, v139
    s_mov_b32 s48, s18
    s_and_b32 s49, s19, 0xffff
    s_mov_b32 s50, 524288
    s_mov_b32 s51, 0x00020000
    s_add_u32 s40, s18, 524288
    s_addc_u32 s41, s19, 0
    s_and_b32 s41, s41, 0xffff
    s_mov_b32 s42, 720896
    s_mov_b32 s43, 0x00020000
    s_lshl_b32 s70, s73, 14
    s_lshl_b32 s71, s74, 12
    s_add_u32 s70, s70, s71
    s_lshl_b32 s71, s75, 11
    s_add_u32 s70, s70, s71
    s_lshl_b32 s71, s3, 9
    s_add_u32 s70, s70, s71
    s_mov_b32 exec_lo, 0x00ff00ff
    s_mov_b32 exec_hi, 0x00ff00ff
    buffer_store_dwordx4 v[136:139], v29, s[48:51], s70 offen sc1
    s_mov_b64 exec, -1
    s_waitcnt lgkmcnt(0)
    s_mov_b64 exec, 1
    ds_add_u32 v226, v227
    s_mov_b64 exec, -1
WS2:
    ds_read_b32 v228, v226
    s_waitcnt lgkmcnt(0)
    v_readfirstlane_b32 s71, v228
    s_nop 3
    s_cmp_ge_u32 s71, 8
    s_cbranch_scc0 WS2
    v_lshl_add_u32 v22, v8, 7, v9
    s_lshl_b32 s70, s3, 12
    s_add_u32 s70, s70, 131072
    v_add_u32 v22, s70, v22
    v_xor_b32 v23, 64, v22
    s_waitcnt vmcnt(1)
    ds_write_b128 v22, v[120:123] offset:0
    ds_write_b128 v23, v[124:127] offset:1024
    ds_write_b128 v22, v[128:131] offset:2048
    ds_write_b128 v23, v[132:135] offset:3072
    s_waitcnt lgkmcnt(0)
    s_mov_b64 exec, 1
    ds_add_u32 v226, v227
    s_mov_b64 exec, -1
WS3:
    ds_read_b32 v228, v226
    s_waitcnt lgkmcnt(0)
    v_readfirstlane_b32 s71, v228
    s_nop 3
    s_cmp_ge_u32 s71, 12
    s_cbranch_scc0 WS3
    ds_read_b128 v[36:39], v17 offset:0
    ds_read_b128 v[40:43], v17 offset:64
    ds_read_b64_tr_b16 v[44:45], v18 offset:0
    ds_read_b64_tr_b16 v[46:47], v18 offset:512
    ds_read_b64_tr_b16 v[48:49], v18 offset:4096
    ds_read_b64_tr_b16 v[50:51], v18 offset:4608
    ds_read_b64_tr_b16 v[52:53], v18 offset:8192
    ds_read_b64_tr_b16 v[54:55], v18 offset:8704
    ds_read_b64_tr_b16 v[56:57], v18 offset:12288
    ds_read_b64_tr_b16 v[58:59], v18 offset:12800
    s_waitcnt lgkmcnt(0)
    v_mfma_f32_16x16x32_bf16 v[140:143], v[44:47], v[36:39], v[140:143]
    v_mfma_f32_16x16x32_bf16 v[140:143], v[48:51], v[40:43], v[140:143]
    v_mfma_f32_16x16x32_bf16 v[144:147], v[52:55], v[36:39], v[144:147]
    v_mfma_f32_16x16x32_bf16 v[144:147], v[56:59], v[40:43], v[144:147]
    s_nop 7
    v_bfi_b32 v140, v248, s96, v140
    v_bfi_b32 v141, v248, s97, v141
    v_bfi_b32 v142, v248, s98, v142
    v_bfi_b32 v143, v248, s99, v143
    v_bfi_b32 v144, v248, s96, v144
    v_bfi_b32 v145, v248, s97, v145
    v_bfi_b32 v146, v248, s98, v146
    v_bfi_b32 v147, v248, s99, v147
    s_mul_i32 s70, s68, 45056
    s_lshl_b32 s71, s73, 11
    s_add_u32 s70, s70, s71
    s_lshl_b32 s71, s3, 9
    s_add_u32 s70, s70, s71
    s_cmp_ge_u32 s2, 176
    s_cselect_b32 s70, 0x40000000, s70
    s_mov_b32 exec_lo, 0x00ff00ff
    s_mov_b32 exec_hi, 0x00ff00ff
    buffer_store_dwordx4 v[140:143], v29, s[40:43], s70 offen sc1
    s_add_u32 s70, s70, 360448
    buffer_store_dwordx4 v[144:147], v29, s[40:43], s70 offen sc1
    s_mov_b64 exec, -1
    s_add_u32 s52, s18, 1245184
    s_addc_u32 s53, s19, 0
    s_and_b32 s53, s53, 0xffff
    s_mov_b32 s54, 524288
    s_mov_b32 s55, 0x00020000
    s_add_u32 s56, s18, 3473408
    s_addc_u32 s57, s19, 0
    s_and_b32 s57, s57, 0xffff
    s_mov_b32 s58, 704512
    s_mov_b32 s59, 0x00020000
    s_add_u32 s60, s18, 1769472
    s_addc_u32 s61, s19, 0
    s_and_b32 s61, s61, 0xffff
    s_mov_b32 s62, 131072
    s_mov_b32 s63, 0x00020000
    s_add_u32 s64, s18, 8388608
    s_addc_u32 s65, s19, 0
    s_and_b32 s65, s65, 0xffff
    s_mov_b32 s66, 8388608
    s_mov_b32 s67, 0x00020000
    s_lshr_b32 s74, s2, 2
    s_and_b32 s75, s2, 3
    v_add_u32 v21, 151552, v20
    v_add_u32 v24, 151552, v16
    s_lshl_b32 s69, s3, 2
    v_and_b32 v28, 1, v4
    v_lshl_add_u32 v28, v28, 2, v6
    v_lshlrev_b32 v28, 1, v28
    v_xor_b32 v28, s69, v28
    v_lshrrev_b32 v26, 1, v7
    v_add_u32 v28, v28, v26
    v_lshl_add_u32 v26, v4, 3, v6
    v_lshlrev_b32 v26, 8, v26
    v_lshl_add_u32 v26, v28, 4, v26
    v_and_b32 v28, 1, v7
    v_lshl_add_u32 v26, v28, 3, v26
    v_add_u32 v26, 0, v26
    s_add_u32 s69, s69, 2
    v_and_b32 v28, 1, v4
    v_lshl_add_u32 v28, v28, 2, v6
    v_lshlrev_b32 v28, 1, v28
    v_xor_b32 v28, s69, v28
    v_lshrrev_b32 v27, 1, v7
    v_add_u32 v28, v28, v27
    v_lshl_add_u32 v27, v4, 3, v6
    v_lshlrev_b32 v27, 8, v27
    v_lshl_add_u32 v27, v28, 4, v27
    v_and_b32 v28, 1, v7
    v_lshl_add_u32 v27, v28, 3, v27
    v_add_u32 v27, 0, v27
    s_mov_b32 s72, 0
PL4:
    s_lshl_b32 s70, s73, 14
    buffer_load_dwordx4 v[36:39], v19, s[48:51], s70 offen sc1
    s_add_u32 s70, s70, 4096
    buffer_load_dwordx4 v[40:43], v19, s[48:51], s70 offen sc1
    s_add_u32 s70, s70, 4096
    buffer_load_dwordx4 v[44:47], v19, s[48:51], s70 offen sc1
    s_add_u32 s70, s70, 4096
    buffer_load_dwordx4 v[48:51], v19, s[48:51], s70 offen sc1
    s_add_u32 s70, s70, 4096
    s_waitcnt vmcnt(0)
    v_mov_b32 v22, 0
    v_xor_b32 v23, s96, v36
    v_xor_b32 v249, s97, v37
    v_or3_b32 v22, v22, v23, v249
    v_xor_b32 v23, s98, v38
    v_xor_b32 v249, s99, v39
    v_or3_b32 v22, v22, v23, v249
    v_xor_b32 v23, s96, v40
    v_xor_b32 v249, s97, v41
    v_or3_b32 v22, v22, v23, v249
    v_xor_b32 v23, s98, v42
    v_xor_b32 v249, s99, v43
    v_or3_b32 v22, v22, v23, v249
    v_xor_b32 v23, s96, v44
    v_xor_b32 v249, s97, v45
    v_or3_b32 v22, v22, v23, v249
    v_xor_b32 v23, s98, v46
    v_xor_b32 v249, s99, v47
    v_or3_b32 v22, v22, v23, v249
    v_xor_b32 v23, s96, v48
    v_xor_b32 v249, s97, v49
    v_or3_b32 v22, v22, v23, v249
    v_xor_b32 v23, s98, v50
    v_xor_b32 v249, s99, v51
    v_or3_b32 v22, v22, v23, v249
    v_and_b32 v22, 0xff, v22
    v_cmp_ne_u32 vcc, 0, v22
    s_nop 3
    s_cmp_eq_u64 vcc, 0
    s_cbranch_scc1 PD4
    s_add_u32 s72, s72, 1
    s_cmp_lt_u32 s72, 20000
    s_cbranch_scc0 PD4
    s_sleep 4
    s_branch PL4
PD4:
    v_and_b32 v36, 0xffffff00, v36
    v_and_b32 v37, 0xffffff00, v37
    v_and_b32 v38, 0xffffff00, v38
    v_and_b32 v39, 0xffffff00, v39
    v_and_b32 v40, 0xffffff00, v40
    v_and_b32 v41, 0xffffff00, v41
    v_and_b32 v42, 0xffffff00, v42
    v_and_b32 v43, 0xffffff00, v43
    v_and_b32 v44, 0xffffff00, v44
    v_and_b32 v45, 0xffffff00, v45
    v_and_b32 v46, 0xffffff00, v46
    v_and_b32 v47, 0xffffff00, v47
    v_and_b32 v48, 0xffffff00, v48
    v_and_b32 v49, 0xffffff00, v49
    v_and_b32 v50, 0xffffff00, v50
    v_and_b32 v51, 0xffffff00, v51
    v_add_f32 v36, v36, v40
    v_add_f32 v44, v44, v48
    v_add_f32 v36, v36, v44
    v_add_f32 v37, v37, v41
    v_add_f32 v45, v45, v49
    v_add_f32 v37, v37, v45
    v_add_f32 v38, v38, v42
    v_add_f32 v46, v46, v50
    v_add_f32 v38, v38, v46
    v_add_f32 v39, v39, v43
    v_add_f32 v47, v47, v51
    v_add_f32 v39, v39, v47
    v_cvt_pk_bf16_f32 v40, v36, v37
    v_cvt_pk_bf16_f32 v41, v38, v39
    ds_write_b64 v21, v[40:41]
    s_waitcnt lgkmcnt(0)
    s_mov_b64 exec, 1
    ds_add_u32 v226, v227
    s_mov_b64 exec, -1
WS5:
    ds_read_b32 v228, v226
    s_waitcnt lgkmcnt(0)
    v_readfirstlane_b32 s71, v228
    s_nop 3
    s_cmp_ge_u32 s71, 16
    s_cbranch_scc0 WS5
    ds_read_b128 v[36:39], v24 offset:0
    ds_read_b128 v[40:43], v24 offset:64
    ds_read_b128 v[44:47], v24 offset:128
    ds_read_b128 v[48:51], v24 offset:192
    v_mov_b32 v56, 0
    v_mov_b32 v57, 0
    v_mov_b32 v58, 0
    v_mov_b32 v59, 0
    v_lshlrev_b32 v25, 16, v5
    v_lshl_add_u32 v25, v4, 4, v25
    s_lshl_b32 s70, s73, 11
    s_lshl_b32 s71, s68, 8
    s_add_u32 s70, s70, s71
    s_lshl_b32 s71, s3, 6
    s_add_u32 s70, s70, s71
    s_waitcnt lgkmcnt(0)
    v_mfma_f32_16x16x32_bf16 v[56:59], v[104:107], v[36:39], v[56:59]
    v_mfma_f32_16x16x32_bf16 v[56:59], v[108:111], v[40:43], v[56:59]
    v_mfma_f32_16x16x32_bf16 v[56:59], v[112:115], v[44:47], v[56:59]
    v_mfma_f32_16x16x32_bf16 v[56:59], v[116:119], v[48:51], v[56:59]
    s_nop 9
    v_bfi_b32 v56, v248, s96, v56
    v_bfi_b32 v57, v248, s97, v57
    v_bfi_b32 v58, v248, s98, v58
    v_bfi_b32 v59, v248, s99, v59
    s_mov_b32 exec_lo, 0x00ff00ff
    s_mov_b32 exec_hi, 0x00ff00ff
    buffer_store_dwordx4 v[56:59], v25, s[52:55], s70 offen sc1
    s_mov_b64 exec, -1
    s_waitcnt lgkmcnt(0)
    s_mov_b64 exec, 1
    ds_add_u32 v226, v227
    s_mov_b64 exec, -1
WS6:
    ds_read_b32 v228, v226
    s_waitcnt lgkmcnt(0)
    v_readfirstlane_b32 s71, v228
    s_nop 3
    s_cmp_ge_u32 s71, 20
    s_cbranch_scc0 WS6
    s_mov_b64 exec, 1
    ds_add_u32 v226, v227 offset:4
    s_mov_b64 exec, -1
    s_lshr_b32 s69, s2, 5
    s_mov_b32 s72, 0
PL7:
    s_lshl_b32 s70, s69, 16
    s_lshl_b32 s71, s3, 14
    s_add_u32 s70, s70, s71
    buffer_load_dwordx4 v[128:131], v30, s[52:55], s70 offen sc1
    buffer_load_dwordx4 v[132:135], v30, s[52:55], s70 offen offset:1024 sc1
    s_waitcnt vmcnt(0)
    v_mov_b32 v22, 0
    v_xor_b32 v23, s96, v128
    v_xor_b32 v249, s97, v129
    v_or3_b32 v22, v22, v23, v249
    v_xor_b32 v23, s98, v130
    v_xor_b32 v249, s99, v131
    v_or3_b32 v22, v22, v23, v249
    v_xor_b32 v23, s96, v132
    v_xor_b32 v249, s97, v133
    v_or3_b32 v22, v22, v23, v249
    v_xor_b32 v23, s98, v134
    v_xor_b32 v249, s99, v135
    v_or3_b32 v22, v22, v23, v249
    v_and_b32 v22, 0xff, v22
    v_cmp_ne_u32 vcc, 0, v22
    s_nop 3
    s_cmp_eq_u64 vcc, 0
    s_cbranch_scc1 PD7
    s_add_u32 s72, s72, 1
    s_cmp_lt_u32 s72, 20000
    s_cbranch_scc0 PD7
    s_sleep 4
    s_branch PL7
PD7:
    v_and_b32 v128, 0xffffff00, v128
    v_and_b32 v129, 0xffffff00, v129
    v_and_b32 v130, 0xffffff00, v130
    v_and_b32 v131, 0xffffff00, v131
    v_and_b32 v132, 0xffffff00, v132
    v_and_b32 v133, 0xffffff00, v133
    v_and_b32 v134, 0xffffff00, v134
    v_and_b32 v135, 0xffffff00, v135
    s_mov_b32 s72, 0
PL8:
    s_lshl_b32 s70, s69, 16
    s_lshl_b32 s71, s3, 14
    s_add_u32 s70, s70, s71
    s_add_u32 s70, s70, 2048
    buffer_load_dwordx4 v[136:139], v30, s[52:55], s70 offen sc1
    s_add_u32 s70, s70, 1024
    buffer_load_dwordx4 v[140:143], v30, s[52:55], s70 offen sc1
    s_add_u32 s70, s70, 1024
    buffer_load_dwordx4 v[144:147], v30, s[52:55], s70 offen sc1
    s_add_u32 s70, s70, 1024
    buffer_load_dwordx4 v[148:151], v30, s[52:55], s70 offen sc1
    s_add_u32 s70, s70, 1024
    buffer_load_dwordx4 v[152:155], v30, s[52:55], s70 offen sc1
    s_add_u32 s70, s70, 1024
    buffer_load_dwordx4 v[156:159], v30, s[52:55], s70 offen sc1
    s_add_u32 s70, s70, 1024
    buffer_load_dwordx4 v[160:163], v30, s[52:55], s70 offen sc1
    s_add_u32 s70, s70, 1024
    buffer_load_dwordx4 v[164:167], v30, s[52:55], s70 offen sc1
    s_add_u32 s70, s70, 1024
    buffer_load_dwordx4 v[168:171], v30, s[52:55], s70 offen sc1
    s_add_u32 s70, s70, 1024
    buffer_load_dwordx4 v[172:175], v30, s[52:55], s70 offen sc1
    s_add_u32 s70, s70, 1024
    buffer_load_dwordx4 v[176:179], v30, s[52:55], s70 offen sc1
    s_add_u32 s70, s70, 1024
    buffer_load_dwordx4 v[180:183], v30, s[52:55], s70 offen sc1
    s_add_u32 s70, s70, 1024
    buffer_load_dwordx4 v[184:187], v30, s[52:55], s70 offen sc1
    s_add_u32 s70, s70, 1024
    buffer_load_dwordx4 v[188:191], v30, s[52:55], s70 offen sc1
    s_add_u32 s70, s70, 1024
    s_waitcnt vmcnt(0)
    v_mov_b32 v22, 0
    v_xor_b32 v23, s96, v136
    v_xor_b32 v249, s97, v137
    v_or3_b32 v22, v22, v23, v249
    v_xor_b32 v23, s98, v138
    v_xor_b32 v249, s99, v139
    v_or3_b32 v22, v22, v23, v249
    v_xor_b32 v23, s96, v140
    v_xor_b32 v249, s97, v141
    v_or3_b32 v22, v22, v23, v249
    v_xor_b32 v23, s98, v142
    v_xor_b32 v249, s99, v143
    v_or3_b32 v22, v22, v23, v249
    v_xor_b32 v23, s96, v144
    v_xor_b32 v249, s97, v145
    v_or3_b32 v22, v22, v23, v249
    v_xor_b32 v23, s98, v146
    v_xor_b32 v249, s99, v147
    v_or3_b32 v22, v22, v23, v249
    v_xor_b32 v23, s96, v148
    v_xor_b32 v249, s97, v149
    v_or3_b32 v22, v22, v23, v249
    v_xor_b32 v23, s98, v150
    v_xor_b32 v249, s99, v151
    v_or3_b32 v22, v22, v23, v249
    v_xor_b32 v23, s96, v152
    v_xor_b32 v249, s97, v153
    v_or3_b32 v22, v22, v23, v249
    v_xor_b32 v23, s98, v154
    v_xor_b32 v249, s99, v155
    v_or3_b32 v22, v22, v23, v249
    v_xor_b32 v23, s96, v156
    v_xor_b32 v249, s97, v157
    v_or3_b32 v22, v22, v23, v249
    v_xor_b32 v23, s98, v158
    v_xor_b32 v249, s99, v159
    v_or3_b32 v22, v22, v23, v249
    v_xor_b32 v23, s96, v160
    v_xor_b32 v249, s97, v161
    v_or3_b32 v22, v22, v23, v249
    v_xor_b32 v23, s98, v162
    v_xor_b32 v249, s99, v163
    v_or3_b32 v22, v22, v23, v249
    v_xor_b32 v23, s96, v164
    v_xor_b32 v249, s97, v165
    v_or3_b32 v22, v22, v23, v249
    v_xor_b32 v23, s98, v166
    v_xor_b32 v249, s99, v167
    v_or3_b32 v22, v22, v23, v249
    v_xor_b32 v23, s96, v168
    v_xor_b32 v249, s97, v169
    v_or3_b32 v22, v22, v23, v249
    v_xor_b32 v23, s98, v170
    v_xor_b32 v249, s99, v171
    v_or3_b32 v22, v22, v23, v249
    v_xor_b32 v23, s96, v172
    v_xor_b32 v249, s97, v173
    v_or3_b32 v22, v22, v23, v249
    v_xor_b32 v23, s98, v174
    v_xor_b32 v249, s99, v175
    v_or3_b32 v22, v22, v23, v249
    v_xor_b32 v23, s96, v176
    v_xor_b32 v249, s97, v177
    v_or3_b32 v22, v22, v23, v249
    v_xor_b32 v23, s98, v178
    v_xor_b32 v249, s99, v179
    v_or3_b32 v22, v22, v23, v249
    v_xor_b32 v23, s96, v180
    v_xor_b32 v249, s97, v181
    v_or3_b32 v22, v22, v23, v249
    v_xor_b32 v23, s98, v182
    v_xor_b32 v249, s99, v183
    v_or3_b32 v22, v22, v23, v249
    v_xor_b32 v23, s96, v184
    v_xor_b32 v249, s97, v185
    v_or3_b32 v22, v22, v23, v249
    v_xor_b32 v23, s98, v186
    v_xor_b32 v249, s99, v187
    v_or3_b32 v22, v22, v23, v249
    v_xor_b32 v23, s96, v188
    v_xor_b32 v249, s97, v189
    v_or3_b32 v22, v22, v23, v249
    v_xor_b32 v23, s98, v190
    v_xor_b32 v249, s99, v191
    v_or3_b32 v22, v22, v23, v249
    v_and_b32 v22, 0xff, v22
    v_cmp_ne_u32 vcc, 0, v22
    s_nop 3
    s_cmp_eq_u64 vcc, 0
    s_cbranch_scc1 PD8
    s_add_u32 s72, s72, 1
    s_cmp_lt_u32 s72, 20000
    s_cbranch_scc0 PD8
    s_sleep 4
    s_branch PL8
PD8:
    v_and_b32 v136, 0xffffff00, v136
    v_and_b32 v137, 0xffffff00, v137
    v_and_b32 v138, 0xffffff00, v138
    v_and_b32 v139, 0xffffff00, v139
    v_and_b32 v140, 0xffffff00, v140
    v_and_b32 v141, 0xffffff00, v141
    v_and_b32 v142, 0xffffff00, v142
    v_and_b32 v143, 0xffffff00, v143
    v_and_b32 v144, 0xffffff00, v144
    v_and_b32 v145, 0xffffff00, v145
    v_and_b32 v146, 0xffffff00, v146
    v_and_b32 v147, 0xffffff00, v147
    v_and_b32 v148, 0xffffff00, v148
    v_and_b32 v149, 0xffffff00, v149
    v_and_b32 v150, 0xffffff00, v150
    v_and_b32 v151, 0xffffff00, v151
    v_and_b32 v152, 0xffffff00, v152
    v_and_b32 v153, 0xffffff00, v153
    v_and_b32 v154, 0xffffff00, v154
    v_and_b32 v155, 0xffffff00, v155
    v_and_b32 v156, 0xffffff00, v156
    v_and_b32 v157, 0xffffff00, v157
    v_and_b32 v158, 0xffffff00, v158
    v_and_b32 v159, 0xffffff00, v159
    v_and_b32 v160, 0xffffff00, v160
    v_and_b32 v161, 0xffffff00, v161
    v_and_b32 v162, 0xffffff00, v162
    v_and_b32 v163, 0xffffff00, v163
    v_and_b32 v164, 0xffffff00, v164
    v_and_b32 v165, 0xffffff00, v165
    v_and_b32 v166, 0xffffff00, v166
    v_and_b32 v167, 0xffffff00, v167
    v_and_b32 v168, 0xffffff00, v168
    v_and_b32 v169, 0xffffff00, v169
    v_and_b32 v170, 0xffffff00, v170
    v_and_b32 v171, 0xffffff00, v171
    v_and_b32 v172, 0xffffff00, v172
    v_and_b32 v173, 0xffffff00, v173
    v_and_b32 v174, 0xffffff00, v174
    v_and_b32 v175, 0xffffff00, v175
    v_and_b32 v176, 0xffffff00, v176
    v_and_b32 v177, 0xffffff00, v177
    v_and_b32 v178, 0xffffff00, v178
    v_and_b32 v179, 0xffffff00, v179
    v_and_b32 v180, 0xffffff00, v180
    v_and_b32 v181, 0xffffff00, v181
    v_and_b32 v182, 0xffffff00, v182
    v_and_b32 v183, 0xffffff00, v183
    v_and_b32 v184, 0xffffff00, v184
    v_and_b32 v185, 0xffffff00, v185
    v_and_b32 v186, 0xffffff00, v186
    v_and_b32 v187, 0xffffff00, v187
    v_and_b32 v188, 0xffffff00, v188
    v_and_b32 v189, 0xffffff00, v189
    v_and_b32 v190, 0xffffff00, v190
    v_and_b32 v191, 0xffffff00, v191
    s_cmp_lg_u32 s3, 2
    s_cbranch_scc1 KP_NOW2
KP_W2L:
    ds_read_b32 v228, v226 offset:4
    s_waitcnt lgkmcnt(0)
    v_readfirstlane_b32 s71, v228
    s_nop 3
    s_cmp_ge_u32 s71, 4
    s_cbranch_scc0 KP_W2L
KP_NOW2:
    v_lshrrev_b32 v14, 1, v2
    v_lshlrev_b32 v14, 4, v14
    s_and_b32 s70, s3, 1
    s_lshl_b32 s70, s70, 5
    v_xor_b32 v14, s70, v14
    v_and_b32 v15, 1, v2
    v_lshlrev_b32 v15, 3, v15
    s_lshl_b32 s71, s3, 13
    s_add_u32 s71, s71, 131072
    v_add_u32 v15, s71, v15
    v_xor_b32 v9, 0, v14
    v_add_u32 v9, v9, v15
    v_cvt_pk_bf16_f32 v128, v128, v129
    v_cvt_pk_bf16_f32 v129, v130, v131
    ds_write_b64 v9, v[128:129] offset:0
    v_cvt_pk_bf16_f32 v132, v132, v133
    v_cvt_pk_bf16_f32 v133, v134, v135
    ds_write_b64 v9, v[132:133] offset:512
    v_xor_b32 v9, 64, v14
    v_add_u32 v9, v9, v15
    v_cvt_pk_bf16_f32 v136, v136, v137
    v_cvt_pk_bf16_f32 v137, v138, v139
    ds_write_b64 v9, v[136:137] offset:1024
    v_cvt_pk_bf16_f32 v140, v140, v141
    v_cvt_pk_bf16_f32 v141, v142, v143
    ds_write_b64 v9, v[140:141] offset:1536
    v_xor_b32 v9, 128, v14
    v_add_u32 v9, v9, v15
    v_cvt_pk_bf16_f32 v144, v144, v145
    v_cvt_pk_bf16_f32 v145, v146, v147
    ds_write_b64 v9, v[144:145] offset:2048
    v_cvt_pk_bf16_f32 v148, v148, v149
    v_cvt_pk_bf16_f32 v149, v150, v151
    ds_write_b64 v9, v[148:149] offset:2560
    v_xor_b32 v9, 192, v14
    v_add_u32 v9, v9, v15
    v_cvt_pk_bf16_f32 v152, v152, v153
    v_cvt_pk_bf16_f32 v153, v154, v155
    ds_write_b64 v9, v[152:153] offset:3072
    v_cvt_pk_bf16_f32 v156, v156, v157
    v_cvt_pk_bf16_f32 v157, v158, v159
    ds_write_b64 v9, v[156:157] offset:3584
    v_xor_b32 v9, 16, v14
    v_add_u32 v9, v9, v15
    v_cvt_pk_bf16_f32 v160, v160, v161
    v_cvt_pk_bf16_f32 v161, v162, v163
    ds_write_b64 v9, v[160:161] offset:4096
    v_cvt_pk_bf16_f32 v164, v164, v165
    v_cvt_pk_bf16_f32 v165, v166, v167
    ds_write_b64 v9, v[164:165] offset:4608
    v_xor_b32 v9, 80, v14
    v_add_u32 v9, v9, v15
    v_cvt_pk_bf16_f32 v168, v168, v169
    v_cvt_pk_bf16_f32 v169, v170, v171
    ds_write_b64 v9, v[168:169] offset:5120
    v_cvt_pk_bf16_f32 v172, v172, v173
    v_cvt_pk_bf16_f32 v173, v174, v175
    ds_write_b64 v9, v[172:173] offset:5632
    v_xor_b32 v9, 144, v14
    v_add_u32 v9, v9, v15
    v_cvt_pk_bf16_f32 v176, v176, v177
    v_cvt_pk_bf16_f32 v177, v178, v179
    ds_write_b64 v9, v[176:177] offset:6144
    v_cvt_pk_bf16_f32 v180, v180, v181
    v_cvt_pk_bf16_f32 v181, v182, v183
    ds_write_b64 v9, v[180:181] offset:6656
    v_xor_b32 v9, 208, v14
    v_add_u32 v9, v9, v15
    v_cvt_pk_bf16_f32 v184, v184, v185
    v_cvt_pk_bf16_f32 v185, v186, v187
    ds_write_b64 v9, v[184:185] offset:7168
    v_cvt_pk_bf16_f32 v188, v188, v189
    v_cvt_pk_bf16_f32 v189, v190, v191
    ds_write_b64 v9, v[188:189] offset:7680
    v_lshlrev_b32 v30, 4, v2
    s_lshr_b32 s69, s2, 5
    v_and_b32 v224, 31, v2
    v_lshrrev_b32 v225, 5, v2
    v_and_b32 v9, 3, v224
    v_lshlrev_b32 v9, 2, v9
    v_lshrrev_b32 v10, 2, v224
    v_and_b32 v10, 3, v10
    v_or_b32 v9, v9, v10
    v_xor_b32 v9, v9, v225
    v_lshlrev_b32 v10, 10, v224
    s_lshl_b32 s70, s3, 15
    v_add_u32 v11, s70, v10
    v_add_u32 v12, 131072, v10
    v_xor_b32 v14, 0, v9
    v_lshl_add_u32 v232, v14, 4, v11
    v_lshl_add_u32 v240, v14, 4, v12
    v_xor_b32 v14, 2, v9
    v_lshl_add_u32 v233, v14, 4, v11
    v_lshl_add_u32 v241, v14, 4, v12
    v_xor_b32 v14, 4, v9
    v_lshl_add_u32 v234, v14, 4, v11
    v_lshl_add_u32 v242, v14, 4, v12
    v_xor_b32 v14, 6, v9
    v_lshl_add_u32 v235, v14, 4, v11
    v_lshl_add_u32 v243, v14, 4, v12
    v_xor_b32 v14, 8, v9
    v_lshl_add_u32 v236, v14, 4, v11
    v_lshl_add_u32 v244, v14, 4, v12
    v_xor_b32 v14, 10, v9
    v_lshl_add_u32 v237, v14, 4, v11
    v_lshl_add_u32 v245, v14, 4, v12
    v_xor_b32 v14, 12, v9
    v_lshl_add_u32 v238, v14, 4, v11
    v_lshl_add_u32 v246, v14, 4, v12
    v_xor_b32 v14, 14, v9
    v_lshl_add_u32 v239, v14, 4, v11
    v_lshl_add_u32 v247, v14, 4, v12
    v_mov_b32 v32, 0
    v_mov_b32 v33, 0
    v_mov_b32 v34, 0
    v_mov_b32 v35, 0
    v_mov_b32 v36, 0
    v_mov_b32 v37, 0
    v_mov_b32 v38, 0
    v_mov_b32 v39, 0
    v_mov_b32 v40, 0
    v_mov_b32 v41, 0
    v_mov_b32 v42, 0
    v_mov_b32 v43, 0
    v_mov_b32 v44, 0
    v_mov_b32 v45, 0
    v_mov_b32 v46, 0
    v_mov_b32 v47, 0
    v_mov_b32 v80, 0
    v_mov_b32 v81, 0
    v_mov_b32 v82, 0
    v_mov_b32 v83, 0
    v_mov_b32 v84, 0
    v_mov_b32 v85, 0
    v_mov_b32 v86, 0
    v_mov_b32 v87, 0
    v_mov_b32 v88, 0
    v_mov_b32 v89, 0
    v_mov_b32 v90, 0
    v_mov_b32 v91, 0
    v_mov_b32 v92, 0
    v_mov_b32 v93, 0
    v_mov_b32 v94, 0
    v_mov_b32 v95, 0
    v_mov_b32 v96, 0
    v_mov_b32 v97, 0
    v_mov_b32 v98, 0
    v_mov_b32 v99, 0
    v_mov_b32 v100, 0
    v_mov_b32 v101, 0
    v_mov_b32 v102, 0
    v_mov_b32 v103, 0
    v_mov_b32 v104, 0
    v_mov_b32 v105, 0
    v_mov_b32 v106, 0
    v_mov_b32 v107, 0
    v_mov_b32 v108, 0
    v_mov_b32 v109, 0
    v_mov_b32 v110, 0
    v_mov_b32 v111, 0
    v_mov_b32 v112, 0
    v_mov_b32 v113, 0
    v_mov_b32 v114, 0
    v_mov_b32 v115, 0
    v_mov_b32 v116, 0
    v_mov_b32 v117, 0
    v_mov_b32 v118, 0
    v_mov_b32 v119, 0
    v_mov_b32 v120, 0
    v_mov_b32 v121, 0
    v_mov_b32 v122, 0
    v_mov_b32 v123, 0
    v_mov_b32 v124, 0
    v_mov_b32 v125, 0
    v_mov_b32 v126, 0
    v_mov_b32 v127, 0
    v_and_b32 v9, 1, v4
    v_lshrrev_b32 v10, 1, v7
    v_lshl_add_u32 v10, v9, 1, v10
    v_lshl_add_u32 v11, v225, 2, v6
    v_lshlrev_b32 v11, 10, v11
    s_lshl_b32 s70, s3, 8
    v_add_u32 v11, s70, v11
    v_and_b32 v9, 1, v7
    v_lshl_add_u32 v11, v9, 3, v11
    v_add_u32 v9, 0, v225
    v_xor_b32 v9, v9, v10
    v_xor_b32 v14, 0, v6
    v_lshl_add_u32 v14, v14, 2, v9
    v_lshl_add_u32 v160, v14, 4, v11
    v_xor_b32 v14, 1, v6
    v_lshl_add_u32 v14, v14, 2, v9
    v_lshl_add_u32 v162, v14, 4, v11
    v_xor_b32 v14, 2, v6
    v_lshl_add_u32 v14, v14, 2, v9
    v_lshl_add_u32 v164, v14, 4, v11
    v_xor_b32 v14, 3, v6
    v_lshl_add_u32 v14, v14, 2, v9
    v_lshl_add_u32 v166, v14, 4, v11
    v_add_u32 v9, 2, v225
    v_xor_b32 v9, v9, v10
    v_xor_b32 v14, 0, v6
    v_lshl_add_u32 v14, v14, 2, v9
    v_lshl_add_u32 v161, v14, 4, v11
    v_add_u32 v161, 8192, v161
    v_xor_b32 v14, 1, v6
    v_lshl_add_u32 v14, v14, 2, v9
    v_lshl_add_u32 v163, v14, 4, v11
    v_add_u32 v163, 8192, v163
    v_xor_b32 v14, 2, v6
    v_lshl_add_u32 v14, v14, 2, v9
    v_lshl_add_u32 v165, v14, 4, v11
    v_add_u32 v165, 8192, v165
    v_xor_b32 v14, 3, v6
    v_lshl_add_u32 v14, v14, 2, v9
    v_lshl_add_u32 v167, v14, 4, v11
    v_add_u32 v167, 8192, v167
    s_waitcnt lgkmcnt(0)
    s_barrier
    ds_read_b128 v[48:51], v232 offset:0
    ds_read_b128 v[64:67], v240 offset:0
    ds_read_b128 v[52:55], v233 offset:0
    ds_read_b128 v[68:71], v241 offset:0
    ds_read_b128 v[56:59], v234 offset:0
    ds_read_b128 v[72:75], v242 offset:0
    ds_read_b128 v[60:63], v235 offset:0
    ds_read_b128 v[76:79], v243 offset:0
    s_waitcnt lgkmcnt(6)
    v_mfma_f32_32x32x16_bf16 v[32:47], v[48:51], v[64:67], v[32:47]
    ds_read_b128 v[48:51], v236 offset:0
    ds_read_b128 v[64:67], v244 offset:0
    s_waitcnt lgkmcnt(6)
    v_mfma_f32_32x32x16_bf16 v[32:47], v[52:55], v[68:71], v[32:47]
    ds_read_b128 v[52:55], v237 offset:0
    ds_read_b128 v[68:71], v245 offset:0
    s_waitcnt lgkmcnt(6)
    v_mfma_f32_32x32x16_bf16 v[32:47], v[56:59], v[72:75], v[32:47]
    s_mov_b32 s36, s10
    s_and_b32 s37, s11, 0xffff
    s_mov_b32 s38, 4194304
    s_mov_b32 s39, 0x00020000
    v_lshlrev_b32 v14, 4, v3
    v_lshl_add_u32 v14, v4, 13, v14
    s_lshr_b32 s70, s68, 1
    s_lshl_b32 s70, s70, 7
    s_and_b32 s71, s68, 1
    s_lshl_b32 s71, s71, 2
    s_add_u32 s70, s70, s71
    s_lshl_b32 s71, s3, 5
    s_add_u32 s70, s70, s71
    s_lshl_b32 s70, s70, 13
    s_lshl_b32 s71, s73, 8
    s_add_u32 s70, s70, s71
    buffer_load_dwordx4 v[192:195], v14, s[36:39], s70 offen nt
    s_add_u32 s70, s70, 65536
    buffer_load_dwordx4 v[196:199], v14, s[36:39], s70 offen nt
    s_add_u32 s70, s70, 65536
    buffer_load_dwordx4 v[200:203], v14, s[36:39], s70 offen nt
    s_add_u32 s70, s70, 65536
    buffer_load_dwordx4 v[204:207], v14, s[36:39], s70 offen nt
    s_add_u32 s70, s70, 65536
    s_mov_b32 s44, s12
    s_and_b32 s45, s13, 0xffff
    s_mov_b32 s46, 4194304
    s_mov_b32 s47, 0x00020000
    v_lshlrev_b32 v14, 4, v5
    v_lshl_add_u32 v14, v8, 10, v14
    s_lshl_b32 s70, s73, 17
    s_lshl_b32 s71, s3, 15
    s_add_u32 s70, s70, s71
    s_lshl_b32 s71, s68, 7
    s_add_u32 s70, s70, s71
    buffer_load_dwordx4 v[208:211], v14, s[44:47], s70 offen nt
    s_add_u32 s70, s70, 8192
    buffer_load_dwordx4 v[212:215], v14, s[44:47], s70 offen nt
    s_add_u32 s70, s70, 8192
    buffer_load_dwordx4 v[216:219], v14, s[44:47], s70 offen nt
    s_add_u32 s70, s70, 8192
    buffer_load_dwordx4 v[220:223], v14, s[44:47], s70 offen nt
    s_add_u32 s70, s70, 8192
    ds_read_b128 v[56:59], v238 offset:0
    ds_read_b128 v[72:75], v246 offset:0
    s_waitcnt lgkmcnt(6)
    v_mfma_f32_32x32x16_bf16 v[32:47], v[60:63], v[76:79], v[32:47]
    ds_read_b128 v[60:63], v239 offset:0
    ds_read_b128 v[76:79], v247 offset:0
    s_waitcnt lgkmcnt(6)
    v_mfma_f32_32x32x16_bf16 v[32:47], v[48:51], v[64:67], v[32:47]
    ds_read_b128 v[48:51], v232 offset:256
    ds_read_b128 v[64:67], v240 offset:256
    s_waitcnt lgkmcnt(6)
    v_mfma_f32_32x32x16_bf16 v[32:47], v[52:55], v[68:71], v[32:47]
    ds_read_b128 v[52:55], v233 offset:256
    ds_read_b128 v[68:71], v241 offset:256
    s_waitcnt lgkmcnt(6)
    v_mfma_f32_32x32x16_bf16 v[32:47], v[56:59], v[72:75], v[32:47]
    ds_read_b128 v[56:59], v234 offset:256
    ds_read_b128 v[72:75], v242 offset:256
    s_waitcnt lgkmcnt(6)
    v_mfma_f32_32x32x16_bf16 v[32:47], v[60:63], v[76:79], v[32:47]
    ds_read_b128 v[60:63], v235 offset:256
    ds_read_b128 v[76:79], v243 offset:256
    s_waitcnt lgkmcnt(6)
    v_mfma_f32_32x32x16_bf16 v[32:47], v[48:51], v[64:67], v[32:47]
    ds_read_b128 v[48:51], v236 offset:256
    ds_read_b128 v[64:67], v244 offset:256
    s_waitcnt lgkmcnt(6)
    v_mfma_f32_32x32x16_bf16 v[32:47], v[52:55], v[68:71], v[32:47]
    ds_read_b128 v[52:55], v237 offset:256
    ds_read_b128 v[68:71], v245 offset:256
    s_waitcnt lgkmcnt(6)
    v_mfma_f32_32x32x16_bf16 v[32:47], v[56:59], v[72:75], v[32:47]
    ds_read_b128 v[56:59], v238 offset:256
    ds_read_b128 v[72:75], v246 offset:256
    s_waitcnt lgkmcnt(6)
    v_mfma_f32_32x32x16_bf16 v[32:47], v[60:63], v[76:79], v[32:47]
    ds_read_b128 v[60:63], v239 offset:256
    ds_read_b128 v[76:79], v247 offset:256
    s_waitcnt lgkmcnt(6)
    v_mfma_f32_32x32x16_bf16 v[32:47], v[48:51], v[64:67], v[32:47]
    ds_read_b128 v[48:51], v232 offset:512
    ds_read_b128 v[64:67], v240 offset:512
    s_waitcnt lgkmcnt(6)
    v_mfma_f32_32x32x16_bf16 v[32:47], v[52:55], v[68:71], v[32:47]
    ds_read_b128 v[52:55], v233 offset:512
    ds_read_b128 v[68:71], v241 offset:512
    s_waitcnt lgkmcnt(6)
    v_mfma_f32_32x32x16_bf16 v[32:47], v[56:59], v[72:75], v[32:47]
    ds_read_b128 v[56:59], v234 offset:512
    ds_read_b128 v[72:75], v242 offset:512
    s_waitcnt lgkmcnt(6)
    v_mfma_f32_32x32x16_bf16 v[32:47], v[60:63], v[76:79], v[32:47]
    ds_read_b128 v[60:63], v235 offset:512
    ds_read_b128 v[76:79], v243 offset:512
    s_waitcnt lgkmcnt(6)
    v_mfma_f32_32x32x16_bf16 v[32:47], v[48:51], v[64:67], v[32:47]
    ds_read_b128 v[48:51], v236 offset:512
    ds_read_b128 v[64:67], v244 offset:512
    s_waitcnt lgkmcnt(6)
    v_mfma_f32_32x32x16_bf16 v[32:47], v[52:55], v[68:71], v[32:47]
    ds_read_b128 v[52:55], v237 offset:512
    ds_read_b128 v[68:71], v245 offset:512
    s_waitcnt lgkmcnt(6)
    v_mfma_f32_32x32x16_bf16 v[32:47], v[56:59], v[72:75], v[32:47]
    ds_read_b128 v[56:59], v238 offset:512
    ds_read_b128 v[72:75], v246 offset:512
    s_waitcnt lgkmcnt(6)
    v_mfma_f32_32x32x16_bf16 v[32:47], v[60:63], v[76:79], v[32:47]
    ds_read_b128 v[60:63], v239 offset:512
    ds_read_b128 v[76:79], v247 offset:512
    s_waitcnt lgkmcnt(6)
    v_mfma_f32_32x32x16_bf16 v[32:47], v[48:51], v[64:67], v[32:47]
    ds_read_b128 v[48:51], v232 offset:768
    ds_read_b128 v[64:67], v240 offset:768
    s_waitcnt lgkmcnt(6)
    v_mfma_f32_32x32x16_bf16 v[32:47], v[52:55], v[68:71], v[32:47]
    ds_read_b128 v[52:55], v233 offset:768
    ds_read_b128 v[68:71], v241 offset:768
    s_waitcnt lgkmcnt(6)
    v_mfma_f32_32x32x16_bf16 v[32:47], v[56:59], v[72:75], v[32:47]
    ds_read_b128 v[56:59], v234 offset:768
    ds_read_b128 v[72:75], v242 offset:768
    s_waitcnt lgkmcnt(6)
    v_mfma_f32_32x32x16_bf16 v[32:47], v[60:63], v[76:79], v[32:47]
    ds_read_b128 v[60:63], v235 offset:768
    ds_read_b128 v[76:79], v243 offset:768
    s_waitcnt lgkmcnt(6)
    v_mfma_f32_32x32x16_bf16 v[32:47], v[48:51], v[64:67], v[32:47]
    ds_read_b128 v[48:51], v236 offset:768
    ds_read_b128 v[64:67], v244 offset:768
    s_waitcnt lgkmcnt(6)
    v_mfma_f32_32x32x16_bf16 v[32:47], v[52:55], v[68:71], v[32:47]
    ds_read_b128 v[52:55], v237 offset:768
    ds_read_b128 v[68:71], v245 offset:768
    s_waitcnt lgkmcnt(6)
    v_mfma_f32_32x32x16_bf16 v[32:47], v[56:59], v[72:75], v[32:47]
    ds_read_b128 v[56:59], v238 offset:768
    ds_read_b128 v[72:75], v246 offset:768
    s_waitcnt lgkmcnt(6)
    v_mfma_f32_32x32x16_bf16 v[32:47], v[60:63], v[76:79], v[32:47]
    ds_read_b128 v[60:63], v239 offset:768
    ds_read_b128 v[76:79], v247 offset:768
    s_waitcnt lgkmcnt(6)
    v_mfma_f32_32x32x16_bf16 v[32:47], v[48:51], v[64:67], v[32:47]
    s_waitcnt lgkmcnt(4)
    v_mfma_f32_32x32x16_bf16 v[32:47], v[52:55], v[68:71], v[32:47]
    s_waitcnt lgkmcnt(2)
    v_mfma_f32_32x32x16_bf16 v[32:47], v[56:59], v[72:75], v[32:47]
    s_waitcnt lgkmcnt(0)
    v_mfma_f32_32x32x16_bf16 v[32:47], v[60:63], v[76:79], v[32:47]
    s_barrier
    v_mov_b32 v64, 0
    v_mov_b32 v65, 0
    v_mov_b32 v66, 0
    v_mov_b32 v67, 0
    v_mov_b32 v68, 0
    v_mov_b32 v69, 0
    v_mov_b32 v70, 0
    v_mov_b32 v71, 0
    v_mov_b32 v72, 0
    v_mov_b32 v73, 0
    v_mov_b32 v74, 0
    v_mov_b32 v75, 0
    v_mov_b32 v76, 0
    v_mov_b32 v77, 0
    v_mov_b32 v78, 0
    v_mov_b32 v79, 0
    s_mov_b32 s70, 0x3db504f3
    v_cvt_pk_bf16_f32 v48, v32, v33
    v_lshlrev_b32 v32, 16, v48
    v_and_b32 v33, 0xffff0000, v48
    v_mul_f32 v32, s70, v32
    v_mul_f32 v33, s70, v33
    v_cvt_pk_bf16_f32 v48, v32, v33
    v_lshlrev_b32 v32, 16, v48
    v_and_b32 v33, 0xffff0000, v48
    v_cvt_pk_bf16_f32 v48, v34, v35
    v_lshlrev_b32 v34, 16, v48
    v_and_b32 v35, 0xffff0000, v48
    v_mul_f32 v34, s70, v34
    v_mul_f32 v35, s70, v35
    v_cvt_pk_bf16_f32 v48, v34, v35
    v_lshlrev_b32 v34, 16, v48
    v_and_b32 v35, 0xffff0000, v48
    v_cvt_pk_bf16_f32 v48, v36, v37
    v_lshlrev_b32 v36, 16, v48
    v_and_b32 v37, 0xffff0000, v48
    v_mul_f32 v36, s70, v36
    v_mul_f32 v37, s70, v37
    v_cvt_pk_bf16_f32 v48, v36, v37
    v_lshlrev_b32 v36, 16, v48
    v_and_b32 v37, 0xffff0000, v48
    v_cvt_pk_bf16_f32 v48, v38, v39
    v_lshlrev_b32 v38, 16, v48
    v_and_b32 v39, 0xffff0000, v48
    v_mul_f32 v38, s70, v38
    v_mul_f32 v39, s70, v39
    v_cvt_pk_bf16_f32 v48, v38, v39
    v_lshlrev_b32 v38, 16, v48
    v_and_b32 v39, 0xffff0000, v48
    v_cvt_pk_bf16_f32 v48, v40, v41
    v_lshlrev_b32 v40, 16, v48
    v_and_b32 v41, 0xffff0000, v48
    v_mul_f32 v40, s70, v40
    v_mul_f32 v41, s70, v41
    v_cvt_pk_bf16_f32 v48, v40, v41
    v_lshlrev_b32 v40, 16, v48
    v_and_b32 v41, 0xffff0000, v48
    v_cvt_pk_bf16_f32 v48, v42, v43
    v_lshlrev_b32 v42, 16, v48
    v_and_b32 v43, 0xffff0000, v48
    v_mul_f32 v42, s70, v42
    v_mul_f32 v43, s70, v43
    v_cvt_pk_bf16_f32 v48, v42, v43
    v_lshlrev_b32 v42, 16, v48
    v_and_b32 v43, 0xffff0000, v48
    v_cvt_pk_bf16_f32 v48, v44, v45
    v_lshlrev_b32 v44, 16, v48
    v_and_b32 v45, 0xffff0000, v48
    v_mul_f32 v44, s70, v44
    v_mul_f32 v45, s70, v45
    v_cvt_pk_bf16_f32 v48, v44, v45
    v_lshlrev_b32 v44, 16, v48
    v_and_b32 v45, 0xffff0000, v48
    v_cvt_pk_bf16_f32 v48, v46, v47
    v_lshlrev_b32 v46, 16, v48
    v_and_b32 v47, 0xffff0000, v48
    v_mul_f32 v46, s70, v46
    v_mul_f32 v47, s70, v47
    v_cvt_pk_bf16_f32 v48, v46, v47
    v_lshlrev_b32 v46, 16, v48
    v_and_b32 v47, 0xffff0000, v48
    v_max3_f32 v48, v32, v33, v34
    v_max3_f32 v48, v48, v35, v36
    v_max3_f32 v48, v48, v37, v38
    v_max3_f32 v48, v48, v39, v40
    v_max3_f32 v48, v48, v41, v42
    v_max3_f32 v48, v48, v43, v44
    v_max3_f32 v48, v48, v45, v46
    v_max_f32 v48, v48, v47
    v_mov_b32 v49, v48
    s_nop 1
    v_permlane32_swap_b32 v48, v49
    v_max_f32 v48, v48, v49
    v_lshlrev_b32 v11, 2, v224
    v_add_u32 v11, 139264, v11
    s_lshl_b32 s70, s3, 7
    v_add_u32 v12, s70, v11
    ds_write_b32 v12, v48
    s_waitcnt lgkmcnt(0)
    s_barrier
    ds_read_b32 v48, v11
    ds_read_b32 v49, v11 offset:128
    ds_read_b32 v50, v11 offset:256
    ds_read_b32 v51, v11 offset:384
    s_waitcnt lgkmcnt(0)
    v_max3_f32 v48, v48, v49, v50
    v_max_f32 v48, v48, v51
    s_mov_b32 s70, 0x3fb8aa3b
    v_mul_f32 v49, s70, v48
    v_fma_f32 v32, v32, s70, -v49
    v_exp_f32 v32, v32
    v_fma_f32 v33, v33, s70, -v49
    v_exp_f32 v33, v33
    v_fma_f32 v34, v34, s70, -v49
    v_exp_f32 v34, v34
    v_fma_f32 v35, v35, s70, -v49
    v_exp_f32 v35, v35
    v_fma_f32 v36, v36, s70, -v49
    v_exp_f32 v36, v36
    v_fma_f32 v37, v37, s70, -v49
    v_exp_f32 v37, v37
    v_fma_f32 v38, v38, s70, -v49
    v_exp_f32 v38, v38
    v_fma_f32 v39, v39, s70, -v49
    v_exp_f32 v39, v39
    v_fma_f32 v40, v40, s70, -v49
    v_exp_f32 v40, v40
    v_fma_f32 v41, v41, s70, -v49
    v_exp_f32 v41, v41
    v_fma_f32 v42, v42, s70, -v49
    v_exp_f32 v42, v42
    v_fma_f32 v43, v43, s70, -v49
    v_exp_f32 v43, v43
    v_fma_f32 v44, v44, s70, -v49
    v_exp_f32 v44, v44
    v_fma_f32 v45, v45, s70, -v49
    v_exp_f32 v45, v45
    v_fma_f32 v46, v46, s70, -v49
    v_exp_f32 v46, v46
    v_fma_f32 v47, v47, s70, -v49
    v_exp_f32 v47, v47
    s_nop 0
    v_add_f32 v50, v32, v33
    v_add_f32 v50, v50, v34
    v_add_f32 v50, v50, v35
    v_add_f32 v50, v50, v36
    v_add_f32 v50, v50, v37
    v_add_f32 v50, v50, v38
    v_add_f32 v50, v50, v39
    v_add_f32 v50, v50, v40
    v_add_f32 v50, v50, v41
    v_add_f32 v50, v50, v42
    v_add_f32 v50, v50, v43
    v_add_f32 v50, v50, v44
    v_add_f32 v50, v50, v45
    v_add_f32 v50, v50, v46
    v_add_f32 v50, v50, v47
    v_mov_b32 v51, v50
    s_nop 1
    v_permlane32_swap_b32 v50, v51
    v_add_f32 v50, v50, v51
    ds_write_b32 v12, v50 offset:512
    v_cvt_pk_bf16_f32 v52, v32, v33
    v_cvt_pk_bf16_f32 v53, v34, v35
    v_cvt_pk_bf16_f32 v54, v36, v37
    v_cvt_pk_bf16_f32 v55, v38, v39
    v_cvt_pk_bf16_f32 v56, v40, v41
    v_cvt_pk_bf16_f32 v57, v42, v43
    v_cvt_pk_bf16_f32 v58, v44, v45
    v_cvt_pk_bf16_f32 v59, v46, v47
    s_lshl_b32 s70, s3, 11
    s_add_u32 s70, s70, 131072
    v_add_u32 v14, s70, v30
    ds_write_b128 v14, v[52:55]
    ds_write_b128 v14, v[56:59] offset:1024
    s_waitcnt lgkmcnt(0)
    s_barrier
    ds_read_b32 v50, v11 offset:512
    ds_read_b32 v51, v11 offset:640
    ds_read_b32 v52, v11 offset:768
    ds_read_b32 v53, v11 offset:896
    v_add_u32 v14, 131072, v30
    ds_read_b128 v[128:131], v14 offset:0
    ds_read_b128 v[132:135], v14 offset:1024
    ds_read_b128 v[136:139], v14 offset:2048
    ds_read_b128 v[140:143], v14 offset:3072
    ds_read_b128 v[144:147], v14 offset:4096
    ds_read_b128 v[148:151], v14 offset:5120
    ds_read_b128 v[152:155], v14 offset:6144
    ds_read_b128 v[156:159], v14 offset:7168
    ds_read_b64_tr_b16 v[168:169], v160 offset:0
    ds_read_b64_tr_b16 v[170:171], v161 offset:0
    ds_read_b64_tr_b16 v[172:173], v162 offset:0
    ds_read_b64_tr_b16 v[174:175], v163 offset:0
    ds_read_b64_tr_b16 v[176:177], v164 offset:0
    ds_read_b64_tr_b16 v[178:179], v165 offset:0
    s_waitcnt lgkmcnt(6)
    v_add_f32 v50, v50, v51
    v_add_f32 v52, v52, v53
    v_add_f32 v49, v50, v52
    v_mov_b32 v230, v48
    v_mov_b32 v231, v49
    ds_read_b64_tr_b16 v[180:181], v166 offset:0
    ds_read_b64_tr_b16 v[182:183], v167 offset:0
    s_waitcnt lgkmcnt(6)
    v_mfma_f32_32x32x16_bf16 v[64:79], v[168:171], v[128:131], v[64:79]
    ds_read_b64_tr_b16 v[168:169], v160 offset:16384
    ds_read_b64_tr_b16 v[170:171], v161 offset:16384
    s_waitcnt lgkmcnt(6)
    v_mfma_f32_32x32x16_bf16 v[80:95], v[172:175], v[128:131], v[80:95]
    ds_read_b64_tr_b16 v[172:173], v162 offset:16384
    ds_read_b64_tr_b16 v[174:175], v163 offset:16384
    s_waitcnt lgkmcnt(6)
    v_mfma_f32_32x32x16_bf16 v[96:111], v[176:179], v[128:131], v[96:111]
    s_add_u32 s40, s18, 524288
    s_addc_u32 s41, s19, 0
    s_and_b32 s41, s41, 0xffff
    s_mov_b32 s42, 720896
    s_mov_b32 s43, 0x00020000
    s_mov_b32 s28, s14
    s_and_b32 s29, s15, 0xffff
    s_mov_b32 s30, 1409024
    s_mov_b32 s31, 0x00020000
    v_lshrrev_b32 v14, 2, v5
    v_lshlrev_b32 v14, 9, v14
    v_lshl_add_u32 v14, v8, 6, v14
    v_lshl_add_u32 v14, v7, 4, v14
    s_and_b32 s70, s3, 1
    s_mul_i32 s70, s70, 360448
    s_lshr_b32 s71, s3, 1
    s_mul_i32 s71, s71, 180224
    s_add_u32 s70, s70, s71
    s_lshl_b32 s71, s74, 10
    s_add_u32 s70, s70, s71
    s_cmp_ge_u32 s2, 172
    s_cselect_b32 s70, 0x40000000, s70
    v_mov_b32 v229, v14
    s_mov_b32 s82, s70
    buffer_load_dwordx4 v[232:235], v14, s[40:43], s70 offen sc1
    s_add_u32 s70, s70, 45056
    buffer_load_dwordx4 v[236:239], v14, s[40:43], s70 offen sc1
    s_add_u32 s70, s70, 45056
    buffer_load_dwordx4 v[240:243], v14, s[40:43], s70 offen sc1
    s_add_u32 s70, s70, 45056
    buffer_load_dwordx4 v[244:247], v14, s[40:43], s70 offen sc1
    s_add_u32 s70, s70, 45056
    v_lshlrev_b32 v14, 4, v3
    v_lshl_add_u32 v14, v4, 10, v14
    s_lshl_b32 s70, s74, 15
    s_lshl_b32 s71, s3, 13
    s_add_u32 s70, s70, s71
    s_lshl_b32 s71, s75, 8
    s_add_u32 s70, s70, s71
    s_cmp_ge_u32 s2, 172
    s_cselect_b32 s70, 0x40000000, s70
    buffer_load_dwordx4 v[184:187], v14, s[28:31], s70 offen nt
    s_add_u32 s70, s70, 4096
    buffer_load_dwordx4 v[188:191], v14, s[28:31], s70 offen nt
    s_add_u32 s70, s70, 4096
    ds_read_b64_tr_b16 v[176:177], v164 offset:16384
    ds_read_b64_tr_b16 v[178:179], v165 offset:16384
    s_waitcnt lgkmcnt(6)
    v_mfma_f32_32x32x16_bf16 v[112:127], v[180:183], v[128:131], v[112:127]
    ds_read_b64_tr_b16 v[180:181], v166 offset:16384
    ds_read_b64_tr_b16 v[182:183], v167 offset:16384
    s_waitcnt lgkmcnt(6)
    v_mfma_f32_32x32x16_bf16 v[64:79], v[168:171], v[132:135], v[64:79]
    ds_read_b64_tr_b16 v[168:169], v160 offset:32768
    ds_read_b64_tr_b16 v[170:171], v161 offset:32768
    s_waitcnt lgkmcnt(6)
    v_mfma_f32_32x32x16_bf16 v[80:95], v[172:175], v[132:135], v[80:95]
    ds_read_b64_tr_b16 v[172:173], v162 offset:32768
    ds_read_b64_tr_b16 v[174:175], v163 offset:32768
    s_waitcnt lgkmcnt(6)
    v_mfma_f32_32x32x16_bf16 v[96:111], v[176:179], v[132:135], v[96:111]
    ds_read_b64_tr_b16 v[176:177], v164 offset:32768
    ds_read_b64_tr_b16 v[178:179], v165 offset:32768
    s_waitcnt lgkmcnt(6)
    v_mfma_f32_32x32x16_bf16 v[112:127], v[180:183], v[132:135], v[112:127]
    ds_read_b64_tr_b16 v[180:181], v166 offset:32768
    ds_read_b64_tr_b16 v[182:183], v167 offset:32768
    s_waitcnt lgkmcnt(6)
    v_mfma_f32_32x32x16_bf16 v[64:79], v[168:171], v[136:139], v[64:79]
    ds_read_b64_tr_b16 v[168:169], v160 offset:49152
    ds_read_b64_tr_b16 v[170:171], v161 offset:49152
    s_waitcnt lgkmcnt(6)
    v_mfma_f32_32x32x16_bf16 v[80:95], v[172:175], v[136:139], v[80:95]
    ds_read_b64_tr_b16 v[172:173], v162 offset:49152
    ds_read_b64_tr_b16 v[174:175], v163 offset:49152
    s_waitcnt lgkmcnt(6)
    v_mfma_f32_32x32x16_bf16 v[96:111], v[176:179], v[136:139], v[96:111]
    ds_read_b64_tr_b16 v[176:177], v164 offset:49152
    ds_read_b64_tr_b16 v[178:179], v165 offset:49152
    s_waitcnt lgkmcnt(6)
    v_mfma_f32_32x32x16_bf16 v[112:127], v[180:183], v[136:139], v[112:127]
    ds_read_b64_tr_b16 v[180:181], v166 offset:49152
    ds_read_b64_tr_b16 v[182:183], v167 offset:49152
    s_waitcnt lgkmcnt(6)
    v_mfma_f32_32x32x16_bf16 v[64:79], v[168:171], v[140:143], v[64:79]
    v_add_u32 v160, 0x10000, v160
    v_add_u32 v161, 0x10000, v161
    v_add_u32 v162, 0x10000, v162
    v_add_u32 v163, 0x10000, v163
    v_add_u32 v164, 0x10000, v164
    v_add_u32 v165, 0x10000, v165
    v_add_u32 v166, 0x10000, v166
    v_add_u32 v167, 0x10000, v167
    ds_read_b64_tr_b16 v[168:169], v160 offset:0
    ds_read_b64_tr_b16 v[170:171], v161 offset:0
    s_waitcnt lgkmcnt(6)
    v_mfma_f32_32x32x16_bf16 v[80:95], v[172:175], v[140:143], v[80:95]
    ds_read_b64_tr_b16 v[172:173], v162 offset:0
    ds_read_b64_tr_b16 v[174:175], v163 offset:0
    s_waitcnt lgkmcnt(6)
    v_mfma_f32_32x32x16_bf16 v[96:111], v[176:179], v[140:143], v[96:111]
    ds_read_b64_tr_b16 v[176:177], v164 offset:0
    ds_read_b64_tr_b16 v[178:179], v165 offset:0
    s_waitcnt lgkmcnt(6)
    v_mfma_f32_32x32x16_bf16 v[112:127], v[180:183], v[140:143], v[112:127]
    ds_read_b64_tr_b16 v[180:181], v166 offset:0
    ds_read_b64_tr_b16 v[182:183], v167 offset:0
    s_waitcnt lgkmcnt(6)
    v_mfma_f32_32x32x16_bf16 v[64:79], v[168:171], v[144:147], v[64:79]
    ds_read_b64_tr_b16 v[168:169], v160 offset:16384
    ds_read_b64_tr_b16 v[170:171], v161 offset:16384
    s_waitcnt lgkmcnt(6)
    v_mfma_f32_32x32x16_bf16 v[80:95], v[172:175], v[144:147], v[80:95]
    ds_read_b64_tr_b16 v[172:173], v162 offset:16384
    ds_read_b64_tr_b16 v[174:175], v163 offset:16384
    s_waitcnt lgkmcnt(6)
    v_mfma_f32_32x32x16_bf16 v[96:111], v[176:179], v[144:147], v[96:111]
    ds_read_b64_tr_b16 v[176:177], v164 offset:16384
    ds_read_b64_tr_b16 v[178:179], v165 offset:16384
    s_waitcnt lgkmcnt(6)
    v_mfma_f32_32x32x16_bf16 v[112:127], v[180:183], v[144:147], v[112:127]
    ds_read_b64_tr_b16 v[180:181], v166 offset:16384
    ds_read_b64_tr_b16 v[182:183], v167 offset:16384
    s_waitcnt lgkmcnt(6)
    v_mfma_f32_32x32x16_bf16 v[64:79], v[168:171], v[148:151], v[64:79]
    ds_read_b64_tr_b16 v[168:169], v160 offset:32768
    ds_read_b64_tr_b16 v[170:171], v161 offset:32768
    s_waitcnt lgkmcnt(6)
    v_mfma_f32_32x32x16_bf16 v[80:95], v[172:175], v[148:151], v[80:95]
    ds_read_b64_tr_b16 v[172:173], v162 offset:32768
    ds_read_b64_tr_b16 v[174:175], v163 offset:32768
    s_waitcnt lgkmcnt(6)
    v_mfma_f32_32x32x16_bf16 v[96:111], v[176:179], v[148:151], v[96:111]
    ds_read_b64_tr_b16 v[176:177], v164 offset:32768
    ds_read_b64_tr_b16 v[178:179], v165 offset:32768
    s_waitcnt lgkmcnt(6)
    v_mfma_f32_32x32x16_bf16 v[112:127], v[180:183], v[148:151], v[112:127]
    ds_read_b64_tr_b16 v[180:181], v166 offset:32768
    ds_read_b64_tr_b16 v[182:183], v167 offset:32768
    s_waitcnt lgkmcnt(6)
    v_mfma_f32_32x32x16_bf16 v[64:79], v[168:171], v[152:155], v[64:79]
    ds_read_b64_tr_b16 v[168:169], v160 offset:49152
    ds_read_b64_tr_b16 v[170:171], v161 offset:49152
    s_waitcnt lgkmcnt(6)
    v_mfma_f32_32x32x16_bf16 v[80:95], v[172:175], v[152:155], v[80:95]
    ds_read_b64_tr_b16 v[172:173], v162 offset:49152
    ds_read_b64_tr_b16 v[174:175], v163 offset:49152
    s_waitcnt lgkmcnt(6)
    v_mfma_f32_32x32x16_bf16 v[96:111], v[176:179], v[152:155], v[96:111]
    ds_read_b64_tr_b16 v[176:177], v164 offset:49152
    ds_read_b64_tr_b16 v[178:179], v165 offset:49152
    s_waitcnt lgkmcnt(6)
    v_mfma_f32_32x32x16_bf16 v[112:127], v[180:183], v[152:155], v[112:127]
    ds_read_b64_tr_b16 v[180:181], v166 offset:49152
    ds_read_b64_tr_b16 v[182:183], v167 offset:49152
    s_waitcnt lgkmcnt(6)
    v_mfma_f32_32x32x16_bf16 v[64:79], v[168:171], v[156:159], v[64:79]
    s_waitcnt lgkmcnt(4)
    v_mfma_f32_32x32x16_bf16 v[80:95], v[172:175], v[156:159], v[80:95]
    s_waitcnt lgkmcnt(2)
    v_mfma_f32_32x32x16_bf16 v[96:111], v[176:179], v[156:159], v[96:111]
    s_waitcnt lgkmcnt(0)
    v_mfma_f32_32x32x16_bf16 v[112:127], v[180:183], v[156:159], v[112:127]
    s_barrier
    v_and_b32 v9, 7, v224
    v_lshlrev_b32 v10, 3, v225
    s_lshl_b32 s70, s3, 4
    v_add_u32 v10, s70, v10
    v_lshlrev_b32 v11, 10, v224
    s_nop 5
    v_cvt_pk_bf16_f32 v128, v64, v65
    v_cvt_pk_bf16_f32 v129, v66, v67
    v_cvt_pk_bf16_f32 v130, v68, v69
    v_cvt_pk_bf16_f32 v131, v70, v71
    v_cvt_pk_bf16_f32 v132, v72, v73
    v_cvt_pk_bf16_f32 v133, v74, v75
    v_cvt_pk_bf16_f32 v134, v76, v77
    v_cvt_pk_bf16_f32 v135, v78, v79
    v_xor_b32 v14, 0, v9
    v_add_u32 v14, v14, v10
    v_lshl_add_u32 v14, v14, 4, v11
    ds_write_b128 v14, v[128:131]
    v_xor_b32 v14, 1, v9
    v_add_u32 v14, v14, v10
    v_lshl_add_u32 v14, v14, 4, v11
    ds_write_b128 v14, v[132:135]
    v_cvt_pk_bf16_f32 v136, v80, v81
    v_cvt_pk_bf16_f32 v137, v82, v83
    v_cvt_pk_bf16_f32 v138, v84, v85
    v_cvt_pk_bf16_f32 v139, v86, v87
    v_cvt_pk_bf16_f32 v140, v88, v89
    v_cvt_pk_bf16_f32 v141, v90, v91
    v_cvt_pk_bf16_f32 v142, v92, v93
    v_cvt_pk_bf16_f32 v143, v94, v95
    v_xor_b32 v14, 2, v9
    v_add_u32 v14, v14, v10
    v_lshl_add_u32 v14, v14, 4, v11
    ds_write_b128 v14, v[136:139]
    v_xor_b32 v14, 3, v9
    v_add_u32 v14, v14, v10
    v_lshl_add_u32 v14, v14, 4, v11
    ds_write_b128 v14, v[140:143]
    v_cvt_pk_bf16_f32 v144, v96, v97
    v_cvt_pk_bf16_f32 v145, v98, v99
    v_cvt_pk_bf16_f32 v146, v100, v101
    v_cvt_pk_bf16_f32 v147, v102, v103
    v_cvt_pk_bf16_f32 v148, v104, v105
    v_cvt_pk_bf16_f32 v149, v106, v107
    v_cvt_pk_bf16_f32 v150, v108, v109
    v_cvt_pk_bf16_f32 v151, v110, v111
    v_xor_b32 v14, 4, v9
    v_add_u32 v14, v14, v10
    v_lshl_add_u32 v14, v14, 4, v11
    ds_write_b128 v14, v[144:147]
    v_xor_b32 v14, 5, v9
    v_add_u32 v14, v14, v10
    v_lshl_add_u32 v14, v14, 4, v11
    ds_write_b128 v14, v[148:151]
    v_cvt_pk_bf16_f32 v152, v112, v113
    v_cvt_pk_bf16_f32 v153, v114, v115
    v_cvt_pk_bf16_f32 v154, v116, v117
    v_cvt_pk_bf16_f32 v155, v118, v119
    v_cvt_pk_bf16_f32 v156, v120, v121
    v_cvt_pk_bf16_f32 v157, v122, v123
    v_cvt_pk_bf16_f32 v158, v124, v125
    v_cvt_pk_bf16_f32 v159, v126, v127
    v_xor_b32 v14, 6, v9
    v_add_u32 v14, v14, v10
    v_lshl_add_u32 v14, v14, 4, v11
    ds_write_b128 v14, v[152:155]
    v_xor_b32 v14, 7, v9
    v_add_u32 v14, v14, v10
    v_lshl_add_u32 v14, v14, 4, v11
    ds_write_b128 v14, v[156:159]
    s_waitcnt lgkmcnt(0)
    s_barrier
    s_lshl_b32 s70, s3, 13
    s_lshl_b32 s71, s2, 15
    s_add_u32 s71, s71, s70
    v_xor_b32 v14, 0, v30
    v_add_u32 v14, s70, v14
    ds_read_b128 v[128:131], v14 offset:0
    v_xor_b32 v14, 16, v30
    v_add_u32 v14, s70, v14
    ds_read_b128 v[132:135], v14 offset:1024
    v_xor_b32 v14, 32, v30
    v_add_u32 v14, s70, v14
    ds_read_b128 v[136:139], v14 offset:2048
    v_xor_b32 v14, 48, v30
    v_add_u32 v14, s70, v14
    ds_read_b128 v[140:143], v14 offset:3072
    v_xor_b32 v14, 64, v30
    v_add_u32 v14, s70, v14
    ds_read_b128 v[144:147], v14 offset:4096
    v_xor_b32 v14, 80, v30
    v_add_u32 v14, s70, v14
    ds_read_b128 v[148:151], v14 offset:5120
    v_xor_b32 v14, 96, v30
    v_add_u32 v14, s70, v14
    ds_read_b128 v[152:155], v14 offset:6144
    v_xor_b32 v14, 112, v30
    v_add_u32 v14, s70, v14
    ds_read_b128 v[156:159], v14 offset:7168
    s_waitcnt lgkmcnt(7)
    buffer_store_dwordx4 v[128:131], v30, s[64:67], s71 offen sc1
    s_add_u32 s71, s71, 1024
    s_waitcnt lgkmcnt(6)
    buffer_store_dwordx4 v[132:135], v30, s[64:67], s71 offen sc1
    s_add_u32 s71, s71, 1024
    s_waitcnt lgkmcnt(5)
    buffer_store_dwordx4 v[136:139], v30, s[64:67], s71 offen sc1
    s_add_u32 s71, s71, 1024
    s_waitcnt lgkmcnt(4)
    buffer_store_dwordx4 v[140:143], v30, s[64:67], s71 offen sc1
    s_add_u32 s71, s71, 1024
    s_waitcnt lgkmcnt(3)
    buffer_store_dwordx4 v[144:147], v30, s[64:67], s71 offen sc1
    s_add_u32 s71, s71, 1024
    s_waitcnt lgkmcnt(2)
    buffer_store_dwordx4 v[148:151], v30, s[64:67], s71 offen sc1
    s_add_u32 s71, s71, 1024
    s_waitcnt lgkmcnt(1)
    buffer_store_dwordx4 v[152:155], v30, s[64:67], s71 offen sc1
    s_add_u32 s71, s71, 1024
    s_waitcnt lgkmcnt(0)
    buffer_store_dwordx4 v[156:159], v30, s[64:67], s71 offen sc1
    s_add_u32 s71, s71, 1024
    s_waitcnt vmcnt(8)
    s_cmp_ge_u32 s2, 172
    s_cbranch_scc1 KP_FPOK
    v_mov_b32 v22, 0
    v_xor_b32 v23, s96, v232
    v_xor_b32 v249, s97, v233
    v_or3_b32 v22, v22, v23, v249
    v_xor_b32 v23, s98, v234
    v_xor_b32 v249, s99, v235
    v_or3_b32 v22, v22, v23, v249
    v_xor_b32 v23, s96, v236
    v_xor_b32 v249, s97, v237
    v_or3_b32 v22, v22, v23, v249
    v_xor_b32 v23, s98, v238
    v_xor_b32 v249, s99, v239
    v_or3_b32 v22, v22, v23, v249
    v_xor_b32 v23, s96, v240
    v_xor_b32 v249, s97, v241
    v_or3_b32 v22, v22, v23, v249
    v_xor_b32 v23, s98, v242
    v_xor_b32 v249, s99, v243
    v_or3_b32 v22, v22, v23, v249
    v_xor_b32 v23, s96, v244
    v_xor_b32 v249, s97, v245
    v_or3_b32 v22, v22, v23, v249
    v_xor_b32 v23, s98, v246
    v_xor_b32 v249, s99, v247
    v_or3_b32 v22, v22, v23, v249
    v_and_b32 v22, 0xff, v22
    v_cmp_ne_u32 vcc, 0, v22
    s_nop 3
    s_cmp_eq_u64 vcc, 0
    s_cbranch_scc1 KP_FPOK
    s_mov_b32 s72, 0
PL9:
    s_mov_b32 s70, s82
    buffer_load_dwordx4 v[232:235], v229, s[40:43], s70 offen sc1
    s_add_u32 s70, s70, 45056
    buffer_load_dwordx4 v[236:239], v229, s[40:43], s70 offen sc1
    s_add_u32 s70, s70, 45056
    buffer_load_dwordx4 v[240:243], v229, s[40:43], s70 offen sc1
    s_add_u32 s70, s70, 45056
    buffer_load_dwordx4 v[244:247], v229, s[40:43], s70 offen sc1
    s_add_u32 s70, s70, 45056
    s_waitcnt vmcnt(0)
    v_mov_b32 v22, 0
    v_xor_b32 v23, s96, v232
    v_xor_b32 v249, s97, v233
    v_or3_b32 v22, v22, v23, v249
    v_xor_b32 v23, s98, v234
    v_xor_b32 v249, s99, v235
    v_or3_b32 v22, v22, v23, v249
    v_xor_b32 v23, s96, v236
    v_xor_b32 v249, s97, v237
    v_or3_b32 v22, v22, v23, v249
    v_xor_b32 v23, s98, v238
    v_xor_b32 v249, s99, v239
    v_or3_b32 v22, v22, v23, v249
    v_xor_b32 v23, s96, v240
    v_xor_b32 v249, s97, v241
    v_or3_b32 v22, v22, v23, v249
    v_xor_b32 v23, s98, v242
    v_xor_b32 v249, s99, v243
    v_or3_b32 v22, v22, v23, v249
    v_xor_b32 v23, s96, v244
    v_xor_b32 v249, s97, v245
    v_or3_b32 v22, v22, v23, v249
    v_xor_b32 v23, s98, v246
    v_xor_b32 v249, s99, v247
    v_or3_b32 v22, v22, v23, v249
    v_and_b32 v22, 0xff, v22
    v_cmp_ne_u32 vcc, 0, v22
    s_nop 3
    s_cmp_eq_u64 vcc, 0
    s_cbranch_scc1 PD9
    s_add_u32 s72, s72, 1
    s_cmp_lt_u32 s72, 20000
    s_cbranch_scc0 PD9
    s_sleep 4
    s_branch PL9
PD9:
KP_FPOK:
    v_and_b32 v232, 0xffffff00, v232
    v_and_b32 v233, 0xffffff00, v233
    v_and_b32 v234, 0xffffff00, v234
    v_and_b32 v235, 0xffffff00, v235
    v_and_b32 v236, 0xffffff00, v236
    v_and_b32 v237, 0xffffff00, v237
    v_and_b32 v238, 0xffffff00, v238
    v_and_b32 v239, 0xffffff00, v239
    v_and_b32 v240, 0xffffff00, v240
    v_and_b32 v241, 0xffffff00, v241
    v_and_b32 v242, 0xffffff00, v242
    v_and_b32 v243, 0xffffff00, v243
    v_and_b32 v244, 0xffffff00, v244
    v_and_b32 v245, 0xffffff00, v245
    v_and_b32 v246, 0xffffff00, v246
    v_and_b32 v247, 0xffffff00, v247
    v_lshl_add_u32 v14, v4, 8, v13
    s_and_b32 s70, s3, 1
    s_lshl_b32 s70, s70, 7
    v_xor_b32 v14, s70, v14
    s_lshl_b32 s70, s3, 11
    s_add_u32 s70, s70, 97280
    v_add_u32 v14, s70, v14
    ds_write_b128 v14, v[184:187]
    ds_write_b128 v14, v[188:191] offset:1024
    v_add_f32 v232, v232, v236
    v_add_f32 v240, v240, v244
    v_add_f32 v232, v232, v240
    v_add_f32 v233, v233, v237
    v_add_f32 v241, v241, v245
    v_add_f32 v233, v233, v241
    v_add_f32 v234, v234, v238
    v_add_f32 v242, v242, v246
    v_add_f32 v234, v234, v242
    v_add_f32 v235, v235, v239
    v_add_f32 v243, v243, v247
    v_add_f32 v235, v235, v243
    v_lshlrev_b32 v21, 4, v0
    v_add_u32 v21, 90112, v21
    ds_write_b128 v21, v[232:235]
    v_lshl_add_u32 v14, v4, 8, v13
    s_lshl_b32 s70, s3, 12
    s_add_u32 s70, s70, 46080
    v_add_u32 v14, s70, v14
    v_xor_b32 v15, 128, v14
    ds_write_b128 v14, v[192:195] offset:0
    ds_write_b128 v14, v[196:199] offset:1024
    ds_write_b128 v15, v[200:203] offset:2048
    ds_write_b128 v15, v[204:207] offset:3072
    v_lshrrev_b32 v14, 1, v8
    v_and_b32 v14, 1, v14
    v_lshlrev_b32 v14, 1, v14
    v_xor_b32 v14, v14, v5
    v_lshlrev_b32 v14, 4, v14
    v_lshl_add_u32 v14, v8, 7, v14
    s_lshl_b32 s70, s3, 12
    s_add_u32 s70, s70, 62464
    v_add_u32 v14, s70, v14
    v_xor_b32 v15, 64, v14
    ds_write_b128 v14, v[208:211] offset:0
    ds_write_b128 v15, v[212:215] offset:1024
    ds_write_b128 v14, v[216:219] offset:2048
    ds_write_b128 v15, v[220:223] offset:3072
    s_waitcnt vmcnt(0) lgkmcnt(0)
    s_barrier
    s_cmp_lg_u32 s3, 0
    s_cbranch_scc1 KP_NOST
    v_lshlrev_b32 v14, 12, v224
    s_lshl_b32 s70, s2, 4
    v_mov_b32 v232, s100
    v_mov_b32 v233, s100
    s_mov_b32 exec_lo, -1
    s_mov_b32 exec_hi, 0
    buffer_store_dwordx4 v[230:233], v14, s[60:63], s70 offen sc1
    s_mov_b64 exec, -1
    ds_read_b128 v[96:99], v21
    ds_read_b128 v[100:103], v21 offset:1024
    ds_read_b128 v[104:107], v21 offset:2048
    ds_read_b128 v[108:111], v21 offset:3072
    s_waitcnt lgkmcnt(0)
    v_add_f32 v96, v96, v104
    v_add_f32 v100, v100, v108
    v_add_f32 v97, v97, v105
    v_add_f32 v101, v101, v109
    v_add_f32 v98, v98, v106
    v_add_f32 v102, v102, v110
    v_add_f32 v99, v99, v107
    v_add_f32 v103, v103, v111
    v_cvt_pk_bf16_f32 v23, v96, v97
    v_lshlrev_b32 v96, 16, v23
    v_and_b32 v97, 0xffff0000, v23
    v_cvt_pk_bf16_f32 v23, v98, v99
    v_lshlrev_b32 v98, 16, v23
    v_and_b32 v99, 0xffff0000, v23
    v_cvt_pk_bf16_f32 v23, v100, v101
    v_lshlrev_b32 v100, 16, v23
    v_and_b32 v101, 0xffff0000, v23
    v_cvt_pk_bf16_f32 v23, v102, v103
    v_lshlrev_b32 v102, 16, v23
    v_and_b32 v103, 0xffff0000, v23
    s_mov_b32 s70, 0x3d372713
    s_mov_b32 s71, 0xc0135761
    v_mul_f32 v23, v96, v96
    v_mul_f32 v23, s70, v23
    v_fma_f32 v23, v23, v96, v96
    v_mul_f32 v23, s71, v23
    v_exp_f32 v23, v23
    s_nop 0
    v_add_f32 v23, 1.0, v23
    v_rcp_f32 v23, v23
    s_nop 0
    v_mul_f32 v96, v96, v23
    v_mul_f32 v23, v97, v97
    v_mul_f32 v23, s70, v23
    v_fma_f32 v23, v23, v97, v97
    v_mul_f32 v23, s71, v23
    v_exp_f32 v23, v23
    s_nop 0
    v_add_f32 v23, 1.0, v23
    v_rcp_f32 v23, v23
    s_nop 0
    v_mul_f32 v97, v97, v23
    v_mul_f32 v23, v98, v98
    v_mul_f32 v23, s70, v23
    v_fma_f32 v23, v23, v98, v98
    v_mul_f32 v23, s71, v23
    v_exp_f32 v23, v23
    s_nop 0
    v_add_f32 v23, 1.0, v23
    v_rcp_f32 v23, v23
    s_nop 0
    v_mul_f32 v98, v98, v23
    v_mul_f32 v23, v99, v99
    v_mul_f32 v23, s70, v23
    v_fma_f32 v23, v23, v99, v99
    v_mul_f32 v23, s71, v23
    v_exp_f32 v23, v23
    s_nop 0
    v_add_f32 v23, 1.0, v23
    v_rcp_f32 v23, v23
    s_nop 0
    v_mul_f32 v99, v99, v23
    v_cvt_pk_bf16_f32 v23, v96, v97
    v_lshlrev_b32 v96, 16, v23
    v_and_b32 v97, 0xffff0000, v23
    v_cvt_pk_bf16_f32 v23, v98, v99
    v_lshlrev_b32 v98, 16, v23
    v_and_b32 v99, 0xffff0000, v23
    v_mul_f32 v96, v96, v100
    v_mul_f32 v97, v97, v101
    v_mul_f32 v98, v98, v102
    v_mul_f32 v99, v99, v103
    v_cvt_pk_bf16_f32 v104, v96, v97
    v_cvt_pk_bf16_f32 v105, v98, v99
    s_mov_b32 s70, 288
    v_mul_lo_u32 v22, v8, s70
    v_lshl_add_u32 v22, v5, 3, v22
    v_add_u32 v22, 94208, v22
    ds_write_b64 v22, v[104:105]
KP_NOST:
    s_waitcnt lgkmcnt(0)
    s_barrier
    v_add_u32 v22, 94208, v16
    ds_read_b128 v[32:35], v22
    v_add_u32 v22, 97280, v26
    v_add_u32 v23, 97280, v27
    ds_read_b64_tr_b16 v[64:65], v22
    ds_read_b64_tr_b16 v[66:67], v22 offset:1024
    ds_read_b64_tr_b16 v[68:69], v23
    ds_read_b64_tr_b16 v[70:71], v23 offset:1024
    v_mov_b32 v72, 0
    v_mov_b32 v73, 0
    v_mov_b32 v74, 0
    v_mov_b32 v75, 0
    v_mov_b32 v76, 0
    v_mov_b32 v77, 0
    v_mov_b32 v78, 0
    v_mov_b32 v79, 0
    s_lshl_b32 s70, s74, 14
    s_lshl_b32 s71, s75, 12
    s_add_u32 s70, s70, s71
    s_lshl_b32 s71, s3, 10
    s_add_u32 s70, s70, s71
    s_cmp_ge_u32 s2, 172
    s_cselect_b32 s70, 0x40000000, s70
    s_waitcnt lgkmcnt(0)
    v_mfma_f32_16x16x32_bf16 v[72:75], v[64:67], v[32:35], v[72:75]
    v_mfma_f32_16x16x32_bf16 v[76:79], v[68:71], v[32:35], v[76:79]
    s_nop 9
    v_bfi_b32 v72, v248, s96, v72
    v_bfi_b32 v73, v248, s97, v73
    v_bfi_b32 v74, v248, s98, v74
    v_bfi_b32 v75, v248, s99, v75
    v_bfi_b32 v76, v248, s96, v76
    v_bfi_b32 v77, v248, s97, v77
    v_bfi_b32 v78, v248, s98, v78
    v_bfi_b32 v79, v248, s99, v79
    s_mov_b32 exec_lo, 0x00ff00ff
    s_mov_b32 exec_hi, 0x00ff00ff
    buffer_store_dwordx4 v[72:75], v29, s[56:59], s70 offen sc1
    buffer_store_dwordx4 v[76:79], v29, s[56:59], s70 offen offset:512 sc1
    s_mov_b64 exec, -1
    s_add_u32 s48, s18, 1900544
    s_addc_u32 s49, s19, 0
    s_and_b32 s49, s49, 0xffff
    s_mov_b32 s50, 1048576
    s_mov_b32 s51, 0x00020000
    s_add_u32 s40, s18, 2949120
    s_addc_u32 s41, s19, 0
    s_and_b32 s41, s41, 0xffff
    s_mov_b32 s42, 524288
    s_mov_b32 s43, 0x00020000
    v_lshlrev_b32 v9, 4, v0
    v_lshlrev_b32 v10, 20, v8
    v_lshl_add_u32 v10, v5, 4, v10
    s_mov_b32 s72, 0
PL10:
    s_lshl_b32 s70, s73, 12
    buffer_load_dwordx4 v[32:35], v9, s[60:63], s70 offen sc1
    s_waitcnt vmcnt(0)
    v_cmp_ne_u32 vcc, s100, v34
    s_nop 3
    s_cmp_eq_u64 vcc, 0
    s_cbranch_scc1 PD10
    s_add_u32 s72, s72, 1
    s_cmp_lt_u32 s72, 20000
    s_cbranch_scc0 PD10
    s_sleep 4
    s_branch PL10
PD10:
    s_barrier
    s_lshl_b32 s70, s3, 18
    s_lshl_b32 s71, s73, 10
    s_add_u32 s70, s70, s71
    s_lshl_b32 s71, s68, 7
    s_add_u32 s70, s70, s71
    buffer_load_dwordx4 v[64:67], v10, s[64:67], s70 offen sc1
    s_add_u32 s70, s70, 32768
    buffer_load_dwordx4 v[68:71], v10, s[64:67], s70 offen sc1
    s_add_u32 s70, s70, 32768
    buffer_load_dwordx4 v[72:75], v10, s[64:67], s70 offen sc1
    s_add_u32 s70, s70, 32768
    buffer_load_dwordx4 v[76:79], v10, s[64:67], s70 offen sc1
    s_add_u32 s70, s70, 32768
    buffer_load_dwordx4 v[80:83], v10, s[64:67], s70 offen sc1
    s_add_u32 s70, s70, 32768
    buffer_load_dwordx4 v[84:87], v10, s[64:67], s70 offen sc1
    s_add_u32 s70, s70, 32768
    buffer_load_dwordx4 v[88:91], v10, s[64:67], s70 offen sc1
    s_add_u32 s70, s70, 32768
    buffer_load_dwordx4 v[92:95], v10, s[64:67], s70 offen sc1
    s_add_u32 s70, s70, 32768
    v_mov_b32 v34, v32
    ds_swizzle_b32 v35, v34 offset:1055
    s_waitcnt lgkmcnt(0)
    v_max_f32 v34, v34, v35
    ds_swizzle_b32 v35, v34 offset:2079
    s_waitcnt lgkmcnt(0)
    v_max_f32 v34, v34, v35
    ds_swizzle_b32 v35, v34 offset:4127
    s_waitcnt lgkmcnt(0)
    v_max_f32 v34, v34, v35
    ds_swizzle_b32 v35, v34 offset:8223
    s_waitcnt lgkmcnt(0)
    v_max_f32 v34, v34, v35
    ds_swizzle_b32 v35, v34 offset:16415
    s_waitcnt lgkmcnt(0)
    v_max_f32 v34, v34, v35
    v_sub_f32 v34, v32, v34
    v_mul_f32 v34, 0x3fb8aa3b, v34
    v_exp_f32 v34, v34
    s_nop 0
    v_mul_f32 v36, v34, v33
    ds_swizzle_b32 v35, v36 offset:1055
    s_waitcnt lgkmcnt(0)
    v_add_f32 v36, v36, v35
    ds_swizzle_b32 v35, v36 offset:2079
    s_waitcnt lgkmcnt(0)
    v_add_f32 v36, v36, v35
    ds_swizzle_b32 v35, v36 offset:4127
    s_waitcnt lgkmcnt(0)
    v_add_f32 v36, v36, v35
    ds_swizzle_b32 v35, v36 offset:8223
    s_waitcnt lgkmcnt(0)
    v_add_f32 v36, v36, v35
    ds_swizzle_b32 v35, v36 offset:16415
    s_waitcnt lgkmcnt(0)
    v_add_f32 v36, v36, v35
    v_rcp_f32 v36, v36
    s_nop 0
    v_mul_f32 v34, v34, v36
    v_lshlrev_b32 v35, 2, v0
    ds_write_b32 v35, v34 offset:32768
    s_waitcnt lgkmcnt(0)
    s_barrier
    v_lshlrev_b32 v35, 7, v8
    s_lshl_b32 s70, s3, 5
    v_add_u32 v35, s70, v35
    ds_read_b128 v[36:39], v35 offset:32768
    ds_read_b128 v[40:43], v35 offset:32784
    v_mov_b32 v48, 0
    v_mov_b32 v49, 0
    v_mov_b32 v50, 0
    v_mov_b32 v51, 0
    v_mov_b32 v52, 0
    v_mov_b32 v53, 0
    v_mov_b32 v54, 0
    v_mov_b32 v55, 0
    s_waitcnt lgkmcnt(0)
    s_waitcnt vmcnt(7)
    v_lshlrev_b32 v22, 16, v64
    v_and_b32 v23, 0xffff0000, v64
    v_fmac_f32 v48, v22, v36
    v_fmac_f32 v49, v23, v36
    v_lshlrev_b32 v22, 16, v65
    v_and_b32 v23, 0xffff0000, v65
    v_fmac_f32 v50, v22, v36
    v_fmac_f32 v51, v23, v36
    v_lshlrev_b32 v22, 16, v66
    v_and_b32 v23, 0xffff0000, v66
    v_fmac_f32 v52, v22, v36
    v_fmac_f32 v53, v23, v36
    v_lshlrev_b32 v22, 16, v67
    v_and_b32 v23, 0xffff0000, v67
    v_fmac_f32 v54, v22, v36
    v_fmac_f32 v55, v23, v36
    s_waitcnt vmcnt(6)
    v_lshlrev_b32 v22, 16, v68
    v_and_b32 v23, 0xffff0000, v68
    v_fmac_f32 v48, v22, v37
    v_fmac_f32 v49, v23, v37
    v_lshlrev_b32 v22, 16, v69
    v_and_b32 v23, 0xffff0000, v69
    v_fmac_f32 v50, v22, v37
    v_fmac_f32 v51, v23, v37
    v_lshlrev_b32 v22, 16, v70
    v_and_b32 v23, 0xffff0000, v70
    v_fmac_f32 v52, v22, v37
    v_fmac_f32 v53, v23, v37
    v_lshlrev_b32 v22, 16, v71
    v_and_b32 v23, 0xffff0000, v71
    v_fmac_f32 v54, v22, v37
    v_fmac_f32 v55, v23, v37
    s_waitcnt vmcnt(5)
    v_lshlrev_b32 v22, 16, v72
    v_and_b32 v23, 0xffff0000, v72
    v_fmac_f32 v48, v22, v38
    v_fmac_f32 v49, v23, v38
    v_lshlrev_b32 v22, 16, v73
    v_and_b32 v23, 0xffff0000, v73
    v_fmac_f32 v50, v22, v38
    v_fmac_f32 v51, v23, v38
    v_lshlrev_b32 v22, 16, v74
    v_and_b32 v23, 0xffff0000, v74
    v_fmac_f32 v52, v22, v38
    v_fmac_f32 v53, v23, v38
    v_lshlrev_b32 v22, 16, v75
    v_and_b32 v23, 0xffff0000, v75
    v_fmac_f32 v54, v22, v38
    v_fmac_f32 v55, v23, v38
    s_waitcnt vmcnt(4)
    v_lshlrev_b32 v22, 16, v76
    v_and_b32 v23, 0xffff0000, v76
    v_fmac_f32 v48, v22, v39
    v_fmac_f32 v49, v23, v39
    v_lshlrev_b32 v22, 16, v77
    v_and_b32 v23, 0xffff0000, v77
    v_fmac_f32 v50, v22, v39
    v_fmac_f32 v51, v23, v39
    v_lshlrev_b32 v22, 16, v78
    v_and_b32 v23, 0xffff0000, v78
    v_fmac_f32 v52, v22, v39
    v_fmac_f32 v53, v23, v39
    v_lshlrev_b32 v22, 16, v79
    v_and_b32 v23, 0xffff0000, v79
    v_fmac_f32 v54, v22, v39
    v_fmac_f32 v55, v23, v39
    s_waitcnt vmcnt(3)
    v_lshlrev_b32 v22, 16, v80
    v_and_b32 v23, 0xffff0000, v80
    v_fmac_f32 v48, v22, v40
    v_fmac_f32 v49, v23, v40
    v_lshlrev_b32 v22, 16, v81
    v_and_b32 v23, 0xffff0000, v81
    v_fmac_f32 v50, v22, v40
    v_fmac_f32 v51, v23, v40
    v_lshlrev_b32 v22, 16, v82
    v_and_b32 v23, 0xffff0000, v82
    v_fmac_f32 v52, v22, v40
    v_fmac_f32 v53, v23, v40
    v_lshlrev_b32 v22, 16, v83
    v_and_b32 v23, 0xffff0000, v83
    v_fmac_f32 v54, v22, v40
    v_fmac_f32 v55, v23, v40
    s_waitcnt vmcnt(2)
    v_lshlrev_b32 v22, 16, v84
    v_and_b32 v23, 0xffff0000, v84
    v_fmac_f32 v48, v22, v41
    v_fmac_f32 v49, v23, v41
    v_lshlrev_b32 v22, 16, v85
    v_and_b32 v23, 0xffff0000, v85
    v_fmac_f32 v50, v22, v41
    v_fmac_f32 v51, v23, v41
    v_lshlrev_b32 v22, 16, v86
    v_and_b32 v23, 0xffff0000, v86
    v_fmac_f32 v52, v22, v41
    v_fmac_f32 v53, v23, v41
    v_lshlrev_b32 v22, 16, v87
    v_and_b32 v23, 0xffff0000, v87
    v_fmac_f32 v54, v22, v41
    v_fmac_f32 v55, v23, v41
    s_waitcnt vmcnt(1)
    v_lshlrev_b32 v22, 16, v88
    v_and_b32 v23, 0xffff0000, v88
    v_fmac_f32 v48, v22, v42
    v_fmac_f32 v49, v23, v42
    v_lshlrev_b32 v22, 16, v89
    v_and_b32 v23, 0xffff0000, v89
    v_fmac_f32 v50, v22, v42
    v_fmac_f32 v51, v23, v42
    v_lshlrev_b32 v22, 16, v90
    v_and_b32 v23, 0xffff0000, v90
    v_fmac_f32 v52, v22, v42
    v_fmac_f32 v53, v23, v42
    v_lshlrev_b32 v22, 16, v91
    v_and_b32 v23, 0xffff0000, v91
    v_fmac_f32 v54, v22, v42
    v_fmac_f32 v55, v23, v42
    s_waitcnt vmcnt(0)
    v_lshlrev_b32 v22, 16, v92
    v_and_b32 v23, 0xffff0000, v92
    v_fmac_f32 v48, v22, v43
    v_fmac_f32 v49, v23, v43
    v_lshlrev_b32 v22, 16, v93
    v_and_b32 v23, 0xffff0000, v93
    v_fmac_f32 v50, v22, v43
    v_fmac_f32 v51, v23, v43
    v_lshlrev_b32 v22, 16, v94
    v_and_b32 v23, 0xffff0000, v94
    v_fmac_f32 v52, v22, v43
    v_fmac_f32 v53, v23, v43
    v_lshlrev_b32 v22, 16, v95
    v_and_b32 v23, 0xffff0000, v95
    v_fmac_f32 v54, v22, v43
    v_fmac_f32 v55, v23, v43
    v_lshlrev_b32 v35, 5, v0
    ds_write_b128 v35, v[48:51] offset:33792
    ds_write_b128 v35, v[52:55] offset:33808
    s_waitcnt lgkmcnt(0)
    s_barrier
    s_cmp_lg_u32 s3, 0
    s_cbranch_scc1 KP_NOSUM
    ds_read_b128 v[56:59], v35 offset:35840
    ds_read_b128 v[60:63], v35 offset:35856
    ds_read_b128 v[64:67], v35 offset:37888
    ds_read_b128 v[68:71], v35 offset:37904
    ds_read_b128 v[72:75], v35 offset:39936
    ds_read_b128 v[76:79], v35 offset:39952
    s_waitcnt lgkmcnt(0)
    v_add_f32 v48, v48, v56
    v_add_f32 v64, v64, v72
    v_add_f32 v48, v48, v64
    v_add_f32 v49, v49, v57
    v_add_f32 v65, v65, v73
    v_add_f32 v49, v49, v65
    v_add_f32 v50, v50, v58
    v_add_f32 v66, v66, v74
    v_add_f32 v50, v50, v66
    v_add_f32 v51, v51, v59
    v_add_f32 v67, v67, v75
    v_add_f32 v51, v51, v67
    v_add_f32 v52, v52, v60
    v_add_f32 v68, v68, v76
    v_add_f32 v52, v52, v68
    v_add_f32 v53, v53, v61
    v_add_f32 v69, v69, v77
    v_add_f32 v53, v53, v69
    v_add_f32 v54, v54, v62
    v_add_f32 v70, v70, v78
    v_add_f32 v54, v54, v70
    v_add_f32 v55, v55, v63
    v_add_f32 v71, v71, v79
    v_add_f32 v55, v55, v71
    v_cvt_pk_bf16_f32 v56, v48, v49
    v_cvt_pk_bf16_f32 v57, v50, v51
    v_cvt_pk_bf16_f32 v58, v52, v53
    v_cvt_pk_bf16_f32 v59, v54, v55
    s_mov_b32 s70, 160
    v_mul_lo_u32 v35, v8, s70
    v_lshl_add_u32 v35, v5, 4, v35
    ds_write_b128 v35, v[56:59] offset:41984
KP_NOSUM:
    s_mov_b32 s70, 160
    v_mul_lo_u32 v24, v5, s70
    v_lshl_add_u32 v24, v4, 4, v24
    v_mov_b32 v96, 0
    v_mov_b32 v97, 0
    v_mov_b32 v98, 0
    v_mov_b32 v99, 0
    v_mov_b32 v100, 0
    v_mov_b32 v101, 0
    v_mov_b32 v102, 0
    v_mov_b32 v103, 0
    s_lshl_b32 s70, s2, 12
    s_lshl_b32 s71, s3, 10
    s_add_u32 s70, s70, s71
    s_waitcnt lgkmcnt(0)
    s_barrier
    ds_read_b128 v[32:35], v24 offset:41984
    ds_read_b64_tr_b16 v[64:65], v26 offset:46080
    ds_read_b64_tr_b16 v[66:67], v26 offset:47104
    ds_read_b64_tr_b16 v[68:69], v27 offset:46080
    ds_read_b64_tr_b16 v[70:71], v27 offset:47104
    ds_read_b128 v[36:39], v24 offset:42048
    ds_read_b64_tr_b16 v[72:73], v26 offset:54272
    ds_read_b64_tr_b16 v[74:75], v26 offset:55296
    ds_read_b64_tr_b16 v[76:77], v27 offset:54272
    ds_read_b64_tr_b16 v[78:79], v27 offset:55296
    s_waitcnt lgkmcnt(0)
    v_mfma_f32_16x16x32_bf16 v[96:99], v[64:67], v[32:35], v[96:99]
    v_mfma_f32_16x16x32_bf16 v[100:103], v[68:71], v[32:35], v[100:103]
    v_mfma_f32_16x16x32_bf16 v[96:99], v[72:75], v[36:39], v[96:99]
    v_mfma_f32_16x16x32_bf16 v[100:103], v[76:79], v[36:39], v[100:103]
    s_nop 9
    v_bfi_b32 v96, v248, s96, v96
    v_bfi_b32 v97, v248, s97, v97
    v_bfi_b32 v98, v248, s98, v98
    v_bfi_b32 v99, v248, s99, v99
    v_bfi_b32 v100, v248, s96, v100
    v_bfi_b32 v101, v248, s97, v101
    v_bfi_b32 v102, v248, s98, v102
    v_bfi_b32 v103, v248, s99, v103
    s_mov_b32 exec_lo, 0x00ff00ff
    s_mov_b32 exec_hi, 0x00ff00ff
    buffer_store_dwordx4 v[96:99], v29, s[48:51], s70 offen sc1
    buffer_store_dwordx4 v[100:103], v29, s[48:51], s70 offen offset:512 sc1
    s_mov_b64 exec, -1
    s_lshl_b32 s69, s3, 1
    v_lshrrev_b32 v27, 1, v6
    v_and_b32 v26, 1, v4
    v_lshl_add_u32 v27, v26, 1, v27
    v_lshlrev_b32 v27, 1, v27
    v_lshrrev_b32 v26, 1, v7
    v_add_u32 v26, s69, v26
    v_xor_b32 v27, v27, v26
    v_lshl_add_u32 v26, v4, 3, v6
    v_lshlrev_b32 v26, 7, v26
    v_lshl_add_u32 v26, v27, 4, v26
    v_and_b32 v27, 1, v7
    v_lshl_add_u32 v26, v27, 3, v26
    v_add_u32 v26, 62464, v26
    s_mov_b32 s72, 0
PL11:
    s_lshl_b32 s70, s73, 15
    buffer_load_dwordx4 v[64:67], v19, s[48:51], s70 offen sc1
    s_add_u32 s70, s70, 4096
    buffer_load_dwordx4 v[68:71], v19, s[48:51], s70 offen sc1
    s_add_u32 s70, s70, 4096
    buffer_load_dwordx4 v[72:75], v19, s[48:51], s70 offen sc1
    s_add_u32 s70, s70, 4096
    buffer_load_dwordx4 v[76:79], v19, s[48:51], s70 offen sc1
    s_add_u32 s70, s70, 4096
    buffer_load_dwordx4 v[80:83], v19, s[48:51], s70 offen sc1
    s_add_u32 s70, s70, 4096
    buffer_load_dwordx4 v[84:87], v19, s[48:51], s70 offen sc1
    s_add_u32 s70, s70, 4096
    buffer_load_dwordx4 v[88:91], v19, s[48:51], s70 offen sc1
    s_add_u32 s70, s70, 4096
    buffer_load_dwordx4 v[92:95], v19, s[48:51], s70 offen sc1
    s_add_u32 s70, s70, 4096
    s_waitcnt vmcnt(0)
    v_mov_b32 v22, 0
    v_xor_b32 v23, s96, v64
    v_xor_b32 v249, s97, v65
    v_or3_b32 v22, v22, v23, v249
    v_xor_b32 v23, s98, v66
    v_xor_b32 v249, s99, v67
    v_or3_b32 v22, v22, v23, v249
    v_xor_b32 v23, s96, v68
    v_xor_b32 v249, s97, v69
    v_or3_b32 v22, v22, v23, v249
    v_xor_b32 v23, s98, v70
    v_xor_b32 v249, s99, v71
    v_or3_b32 v22, v22, v23, v249
    v_xor_b32 v23, s96, v72
    v_xor_b32 v249, s97, v73
    v_or3_b32 v22, v22, v23, v249
    v_xor_b32 v23, s98, v74
    v_xor_b32 v249, s99, v75
    v_or3_b32 v22, v22, v23, v249
    v_xor_b32 v23, s96, v76
    v_xor_b32 v249, s97, v77
    v_or3_b32 v22, v22, v23, v249
    v_xor_b32 v23, s98, v78
    v_xor_b32 v249, s99, v79
    v_or3_b32 v22, v22, v23, v249
    v_xor_b32 v23, s96, v80
    v_xor_b32 v249, s97, v81
    v_or3_b32 v22, v22, v23, v249
    v_xor_b32 v23, s98, v82
    v_xor_b32 v249, s99, v83
    v_or3_b32 v22, v22, v23, v249
    v_xor_b32 v23, s96, v84
    v_xor_b32 v249, s97, v85
    v_or3_b32 v22, v22, v23, v249
    v_xor_b32 v23, s98, v86
    v_xor_b32 v249, s99, v87
    v_or3_b32 v22, v22, v23, v249
    v_xor_b32 v23, s96, v88
    v_xor_b32 v249, s97, v89
    v_or3_b32 v22, v22, v23, v249
    v_xor_b32 v23, s98, v90
    v_xor_b32 v249, s99, v91
    v_or3_b32 v22, v22, v23, v249
    v_xor_b32 v23, s96, v92
    v_xor_b32 v249, s97, v93
    v_or3_b32 v22, v22, v23, v249
    v_xor_b32 v23, s98, v94
    v_xor_b32 v249, s99, v95
    v_or3_b32 v22, v22, v23, v249
    v_and_b32 v22, 0xff, v22
    v_cmp_ne_u32 vcc, 0, v22
    s_nop 3
    s_cmp_eq_u64 vcc, 0
    s_cbranch_scc1 PD11
    s_add_u32 s72, s72, 1
    s_cmp_lt_u32 s72, 20000
    s_cbranch_scc0 PD11
    s_sleep 4
    s_branch PL11
PD11:
    v_and_b32 v64, 0xffffff00, v64
    v_and_b32 v65, 0xffffff00, v65
    v_and_b32 v66, 0xffffff00, v66
    v_and_b32 v67, 0xffffff00, v67
    v_and_b32 v68, 0xffffff00, v68
    v_and_b32 v69, 0xffffff00, v69
    v_and_b32 v70, 0xffffff00, v70
    v_and_b32 v71, 0xffffff00, v71
    v_and_b32 v72, 0xffffff00, v72
    v_and_b32 v73, 0xffffff00, v73
    v_and_b32 v74, 0xffffff00, v74
    v_and_b32 v75, 0xffffff00, v75
    v_and_b32 v76, 0xffffff00, v76
    v_and_b32 v77, 0xffffff00, v77
    v_and_b32 v78, 0xffffff00, v78
    v_and_b32 v79, 0xffffff00, v79
    v_and_b32 v80, 0xffffff00, v80
    v_and_b32 v81, 0xffffff00, v81
    v_and_b32 v82, 0xffffff00, v82
    v_and_b32 v83, 0xffffff00, v83
    v_and_b32 v84, 0xffffff00, v84
    v_and_b32 v85, 0xffffff00, v85
    v_and_b32 v86, 0xffffff00, v86
    v_and_b32 v87, 0xffffff00, v87
    v_and_b32 v88, 0xffffff00, v88
    v_and_b32 v89, 0xffffff00, v89
    v_and_b32 v90, 0xffffff00, v90
    v_and_b32 v91, 0xffffff00, v91
    v_and_b32 v92, 0xffffff00, v92
    v_and_b32 v93, 0xffffff00, v93
    v_and_b32 v94, 0xffffff00, v94
    v_and_b32 v95, 0xffffff00, v95
    v_add_f32 v64, v64, v68
    v_add_f32 v72, v72, v76
    v_add_f32 v80, v80, v84
    v_add_f32 v88, v88, v92
    v_add_f32 v64, v64, v72
    v_add_f32 v80, v80, v88
    v_add_f32 v64, v64, v80
    v_add_f32 v65, v65, v69
    v_add_f32 v73, v73, v77
    v_add_f32 v81, v81, v85
    v_add_f32 v89, v89, v93
    v_add_f32 v65, v65, v73
    v_add_f32 v81, v81, v89
    v_add_f32 v65, v65, v81
    v_add_f32 v66, v66, v70
    v_add_f32 v74, v74, v78
    v_add_f32 v82, v82, v86
    v_add_f32 v90, v90, v94
    v_add_f32 v66, v66, v74
    v_add_f32 v82, v82, v90
    v_add_f32 v66, v66, v82
    v_add_f32 v67, v67, v71
    v_add_f32 v75, v75, v79
    v_add_f32 v83, v83, v87
    v_add_f32 v91, v91, v95
    v_add_f32 v67, v67, v75
    v_add_f32 v83, v83, v91
    v_add_f32 v67, v67, v83
    v_cvt_pk_bf16_f32 v68, v64, v65
    v_cvt_pk_bf16_f32 v69, v66, v67
    ds_write_b64 v20, v[68:69] offset:43264
    v_mov_b32 v56, 0
    v_mov_b32 v57, 0
    v_mov_b32 v58, 0
    v_mov_b32 v59, 0
    s_lshl_b32 s70, s73, 14
    s_lshl_b32 s71, s68, 11
    s_add_u32 s70, s70, s71
    s_lshl_b32 s71, s3, 9
    s_add_u32 s70, s70, s71
    s_waitcnt lgkmcnt(0)
    s_barrier
    ds_read_b128 v[32:35], v16 offset:43264
    ds_read_b64_tr_b16 v[64:65], v26 offset:0
    ds_read_b64_tr_b16 v[66:67], v26 offset:512
    ds_read_b128 v[36:39], v16 offset:43328
    ds_read_b64_tr_b16 v[68:69], v26 offset:4096
    ds_read_b64_tr_b16 v[70:71], v26 offset:4608
    ds_read_b128 v[40:43], v16 offset:43392
    ds_read_b64_tr_b16 v[72:73], v26 offset:8192
    ds_read_b64_tr_b16 v[74:75], v26 offset:8704
    ds_read_b128 v[44:47], v16 offset:43456
    ds_read_b64_tr_b16 v[76:77], v26 offset:12288
    ds_read_b64_tr_b16 v[78:79], v26 offset:12800
    s_waitcnt lgkmcnt(9)
    v_mfma_f32_16x16x32_bf16 v[56:59], v[64:67], v[32:35], v[56:59]
    s_waitcnt lgkmcnt(6)
    v_mfma_f32_16x16x32_bf16 v[56:59], v[68:71], v[36:39], v[56:59]
    s_waitcnt lgkmcnt(3)
    v_mfma_f32_16x16x32_bf16 v[56:59], v[72:75], v[40:43], v[56:59]
    s_waitcnt lgkmcnt(0)
    v_mfma_f32_16x16x32_bf16 v[56:59], v[76:79], v[44:47], v[56:59]
    s_nop 9
    v_bfi_b32 v56, v248, s96, v56
    v_bfi_b32 v57, v248, s97, v57
    v_bfi_b32 v58, v248, s98, v58
    v_bfi_b32 v59, v248, s99, v59
    s_mov_b32 exec_lo, 0x00ff00ff
    s_mov_b32 exec_hi, 0x00ff00ff
    buffer_store_dwordx4 v[56:59], v29, s[40:43], s70 offen sc1
    s_mov_b64 exec, -1
    s_mov_b32 s20, s4
    s_and_b32 s21, s5, 0xffff
    s_mov_b32 s22, 8192
    s_mov_b32 s23, 0x00020000
    s_mov_b32 s28, s16
    s_and_b32 s29, s17, 0xffff
    s_mov_b32 s30, 8192
    s_mov_b32 s31, 0x00020000
    v_and_b32 v9, 3, v0
    v_lshrrev_b32 v10, 2, v0
    v_lshlrev_b32 v11, 14, v10
    v_lshl_add_u32 v11, v9, 4, v11
    v_lshlrev_b32 v12, 1, v0
    s_lshl_b32 s69, s2, 5
    buffer_load_ushort v40, v12, s[20:23], s69 offen
    v_cmp_gt_u32 s[76:77], 32, v10
    v_cmp_gt_u32 s[78:79], 43, v10
    s_nop 1
    s_mov_b32 s72, 0
PL12:
    s_and_b32 s70, s2, 31
    s_lshl_b32 s70, s70, 9
    s_lshr_b32 s71, s2, 5
    s_lshl_b32 s71, s71, 6
    s_add_u32 s70, s70, s71
    buffer_load_dwordx4 v[64:67], v11, s[40:43], s70 offen sc1
    buffer_load_dwordx4 v[68:71], v11, s[56:59], s70 offen sc1
    s_waitcnt vmcnt(0)
    v_mov_b32 v22, 0
    v_xor_b32 v23, s96, v64
    v_xor_b32 v249, s97, v65
    v_or_b32 v23, v23, v249
    v_xor_b32 v249, s98, v66
    v_or_b32 v23, v23, v249
    v_xor_b32 v249, s99, v67
    v_or_b32 v23, v23, v249
    v_cndmask_b32 v23, 0, v23, s[76:77]
    v_or_b32 v22, v22, v23
    v_xor_b32 v23, s96, v68
    v_xor_b32 v249, s97, v69
    v_or_b32 v23, v23, v249
    v_xor_b32 v249, s98, v70
    v_or_b32 v23, v23, v249
    v_xor_b32 v249, s99, v71
    v_or_b32 v23, v23, v249
    v_cndmask_b32 v23, 0, v23, s[78:79]
    v_or_b32 v22, v22, v23
    v_and_b32 v22, 0xff, v22
    v_cmp_ne_u32 vcc, 0, v22
    s_nop 3
    s_cmp_eq_u64 vcc, 0
    s_cbranch_scc1 PD12
    s_add_u32 s72, s72, 1
    s_cmp_lt_u32 s72, 20000
    s_cbranch_scc0 PD12
    s_sleep 4
    s_branch PL12
PD12:
    v_and_b32 v64, 0xffffff00, v64
    v_and_b32 v65, 0xffffff00, v65
    v_and_b32 v66, 0xffffff00, v66
    v_and_b32 v67, 0xffffff00, v67
    v_and_b32 v68, 0xffffff00, v68
    v_and_b32 v69, 0xffffff00, v69
    v_and_b32 v70, 0xffffff00, v70
    v_and_b32 v71, 0xffffff00, v71
    v_lshlrev_b32 v14, 4, v0
    v_add_u32 v14, 81920, v14
    ds_write_b128 v14, v[64:67]
    ds_write_b128 v14, v[68:71] offset:4096
    s_waitcnt lgkmcnt(0)
    s_barrier
    v_cmp_gt_u32 vcc, 16, v0
    s_and_saveexec_b64 s[80:81], vcc
    s_cbranch_execz KP_FIN
    v_lshlrev_b32 v14, 2, v0
    v_add_u32 v14, 81920, v14
    ds_read_b32 v64, v14 offset:0
    ds_read_b32 v65, v14 offset:64
    ds_read_b32 v66, v14 offset:128
    ds_read_b32 v67, v14 offset:192
    ds_read_b32 v68, v14 offset:256
    ds_read_b32 v69, v14 offset:320
    ds_read_b32 v70, v14 offset:384
    ds_read_b32 v71, v14 offset:448
    ds_read_b32 v72, v14 offset:512
    ds_read_b32 v73, v14 offset:576
    ds_read_b32 v74, v14 offset:640
    ds_read_b32 v75, v14 offset:704
    ds_read_b32 v76, v14 offset:768
    ds_read_b32 v77, v14 offset:832
    ds_read_b32 v78, v14 offset:896
    ds_read_b32 v79, v14 offset:960
    ds_read_b32 v80, v14 offset:1024
    ds_read_b32 v81, v14 offset:1088
    ds_read_b32 v82, v14 offset:1152
    ds_read_b32 v83, v14 offset:1216
    ds_read_b32 v84, v14 offset:1280
    ds_read_b32 v85, v14 offset:1344
    ds_read_b32 v86, v14 offset:1408
    ds_read_b32 v87, v14 offset:1472
    ds_read_b32 v88, v14 offset:1536
    ds_read_b32 v89, v14 offset:1600
    ds_read_b32 v90, v14 offset:1664
    ds_read_b32 v91, v14 offset:1728
    ds_read_b32 v92, v14 offset:1792
    ds_read_b32 v93, v14 offset:1856
    ds_read_b32 v94, v14 offset:1920
    ds_read_b32 v95, v14 offset:1984
    ds_read_b32 v128, v14 offset:4096
    ds_read_b32 v129, v14 offset:4160
    ds_read_b32 v130, v14 offset:4224
    ds_read_b32 v131, v14 offset:4288
    ds_read_b32 v132, v14 offset:4352
    ds_read_b32 v133, v14 offset:4416
    ds_read_b32 v134, v14 offset:4480
    ds_read_b32 v135, v14 offset:4544
    ds_read_b32 v136, v14 offset:4608
    ds_read_b32 v137, v14 offset:4672
    ds_read_b32 v138, v14 offset:4736
    ds_read_b32 v139, v14 offset:4800
    ds_read_b32 v140, v14 offset:4864
    ds_read_b32 v141, v14 offset:4928
    ds_read_b32 v142, v14 offset:4992
    ds_read_b32 v143, v14 offset:5056
    ds_read_b32 v144, v14 offset:5120
    ds_read_b32 v145, v14 offset:5184
    ds_read_b32 v146, v14 offset:5248
    ds_read_b32 v147, v14 offset:5312
    ds_read_b32 v148, v14 offset:5376
    ds_read_b32 v149, v14 offset:5440
    ds_read_b32 v150, v14 offset:5504
    ds_read_b32 v151, v14 offset:5568
    ds_read_b32 v152, v14 offset:5632
    ds_read_b32 v153, v14 offset:5696
    ds_read_b32 v154, v14 offset:5760
    ds_read_b32 v155, v14 offset:5824
    ds_read_b32 v156, v14 offset:5888
    ds_read_b32 v157, v14 offset:5952
    ds_read_b32 v158, v14 offset:6016
    ds_read_b32 v159, v14 offset:6080
    ds_read_b32 v160, v14 offset:6144
    ds_read_b32 v161, v14 offset:6208
    ds_read_b32 v162, v14 offset:6272
    ds_read_b32 v163, v14 offset:6336
    ds_read_b32 v164, v14 offset:6400
    ds_read_b32 v165, v14 offset:6464
    ds_read_b32 v166, v14 offset:6528
    ds_read_b32 v167, v14 offset:6592
    ds_read_b32 v168, v14 offset:6656
    ds_read_b32 v169, v14 offset:6720
    ds_read_b32 v170, v14 offset:6784
    s_waitcnt lgkmcnt(0)
    v_add_f32 v64, v64, v80
    v_add_f32 v65, v65, v81
    v_add_f32 v66, v66, v82
    v_add_f32 v67, v67, v83
    v_add_f32 v68, v68, v84
    v_add_f32 v69, v69, v85
    v_add_f32 v70, v70, v86
    v_add_f32 v71, v71, v87
    v_add_f32 v72, v72, v88
    v_add_f32 v73, v73, v89
    v_add_f32 v74, v74, v90
    v_add_f32 v75, v75, v91
    v_add_f32 v76, v76, v92
    v_add_f32 v77, v77, v93
    v_add_f32 v78, v78, v94
    v_add_f32 v79, v79, v95
    v_add_f32 v64, v64, v72
    v_add_f32 v65, v65, v73
    v_add_f32 v66, v66, v74
    v_add_f32 v67, v67, v75
    v_add_f32 v68, v68, v76
    v_add_f32 v69, v69, v77
    v_add_f32 v70, v70, v78
    v_add_f32 v71, v71, v79
    v_add_f32 v64, v64, v68
    v_add_f32 v65, v65, v69
    v_add_f32 v66, v66, v70
    v_add_f32 v67, v67, v71
    v_add_f32 v64, v64, v66
    v_add_f32 v65, v65, v67
    v_add_f32 v64, v64, v65
    v_add_f32 v128, v128, v160
    v_add_f32 v129, v129, v161
    v_add_f32 v130, v130, v162
    v_add_f32 v131, v131, v163
    v_add_f32 v132, v132, v164
    v_add_f32 v133, v133, v165
    v_add_f32 v134, v134, v166
    v_add_f32 v135, v135, v167
    v_add_f32 v136, v136, v168
    v_add_f32 v137, v137, v169
    v_add_f32 v138, v138, v170
    v_add_f32 v128, v128, v144
    v_add_f32 v129, v129, v145
    v_add_f32 v130, v130, v146
    v_add_f32 v131, v131, v147
    v_add_f32 v132, v132, v148
    v_add_f32 v133, v133, v149
    v_add_f32 v134, v134, v150
    v_add_f32 v135, v135, v151
    v_add_f32 v136, v136, v152
    v_add_f32 v137, v137, v153
    v_add_f32 v138, v138, v154
    v_add_f32 v139, v139, v155
    v_add_f32 v140, v140, v156
    v_add_f32 v141, v141, v157
    v_add_f32 v142, v142, v158
    v_add_f32 v143, v143, v159
    v_add_f32 v128, v128, v136
    v_add_f32 v129, v129, v137
    v_add_f32 v130, v130, v138
    v_add_f32 v131, v131, v139
    v_add_f32 v132, v132, v140
    v_add_f32 v133, v133, v141
    v_add_f32 v134, v134, v142
    v_add_f32 v135, v135, v143
    v_add_f32 v128, v128, v132
    v_add_f32 v129, v129, v133
    v_add_f32 v130, v130, v134
    v_add_f32 v131, v131, v135
    v_add_f32 v128, v128, v130
    v_add_f32 v129, v129, v131
    v_add_f32 v128, v128, v129
    v_lshlrev_b32 v40, 16, v40
    v_cvt_pk_bf16_f32 v15, v64, v128
    v_lshlrev_b32 v64, 16, v15
    v_and_b32 v128, 0xffff0000, v15
    v_add_f32 v64, v64, v40
    v_cvt_pk_bf16_f32 v15, v64, v64
    v_lshlrev_b32 v64, 16, v15
    v_and_b32 v65, 0xffff0000, v15
    v_add_f32 v64, v64, v128
    v_cvt_pk_bf16_f32 v64, v64, v64
    buffer_store_short v64, v12, s[28:31], s69 offen
KP_FIN:
    s_mov_b64 exec, s[80:81]
    s_branch KP_EXIT
KP_LOADER:
    s_and_b32 s45, s45, 0xffff
    s_mov_b32 s46, 256
    s_mov_b32 s47, 0x00020000
    s_sub_u32 s69, s3, 4
    v_lshlrev_b32 v3, 4, v2
    s_lshl_b32 s70, s2, 17
    s_lshl_b32 s71, s69, 15
    s_add_u32 s70, s70, s71
    v_mov_b32 v5, 154624
    s_mov_b32 s76, 0
    s_barrier
    s_cmp_lg_u32 s69, 3
    s_cbranch_scc1 KP_LROW
    v_mov_b32 v7, 0
    s_mov_b32 s72, 0
PL13:
    buffer_load_dword v6, v7, s[44:47], 0 offen sc1
    s_waitcnt vmcnt(0)
    v_cmp_eq_u32 vcc, 0, v6
    s_nop 3
    s_cmp_eq_u64 vcc, 0
    s_cbranch_scc1 PD13
    s_add_u32 s72, s72, 1
    s_cmp_lt_u32 s72, 20000
    s_cbranch_scc0 PD13
    s_sleep 8
    s_branch PL13
PD13:
    v_or_b32 v6, 1, v6
    ds_write_b32 v5, v6 offset:12
KP_LROW:
    s_and_b32 s77, s76, 3
    s_lshl_b32 s77, s77, 2
    s_lshr_b32 s78, s76, 2
    s_and_b32 s78, s78, 3
    s_or_b32 s77, s77, s78
    s_lshl_b32 s77, s77, 4
    v_xor_b32 v4, s77, v3
    s_mov_b32 m0, s71
    s_add_u32 s71, s71, 1024
    buffer_load_dwordx4 v4, s[24:27], s70 offen nt lds
    s_add_u32 s70, s70, 1024
    s_cmp_ge_u32 s76, 0
    s_cbranch_scc1 KP_LT2
    s_waitcnt vmcnt(1)
KP_LT2:
    s_waitcnt vmcnt(5)
    s_add_u32 s76, s76, 1
    s_cmp_lt_u32 s76, 32
    s_cbranch_scc1 KP_LROW
    s_waitcnt vmcnt(0)
    s_barrier
KP_EXIT:
    s_endpgm
.section .rodata,"a"
.p2align 6
.amdhsa_kernel parallel_sum__compressed_kv_cla__geglu_ffn__decode_kernel
  .amdhsa_next_free_vgpr 256
  .amdhsa_next_free_sgpr 102
  .amdhsa_accum_offset 256
  .amdhsa_group_segment_fixed_size 0
  .amdhsa_kernarg_size 104
  .amdhsa_user_sgpr_count 2
  .amdhsa_user_sgpr_kernarg_segment_ptr 1
  .amdhsa_system_sgpr_workgroup_id_x 1
.end_amdhsa_kernel
```
